```python
import torch

def _softmax(x, axis=-1):
    return torch.softmax(x, dim=axis)
def _gelu(x):
    return torch.nn.functional.gelu(x, approximate="tanh")
def _silu(x):
    return torch.nn.functional.silu(x)
def _sigmoid(x):
    return torch.sigmoid(x)
def _layernorm(x, axis=-1, eps=1e-5):
    m = x.mean(dim=axis, keepdim=True)
    v = x.var(dim=axis, keepdim=True, unbiased=False)
    return (x - m) / torch.sqrt(v + eps)
def _scatter_add(tgt, idx, src, axis=0):
    return tgt.clone().index_add_(axis, idx, src)
def _segment_sum(src, seg, n):
    out = torch.zeros((n,) + src.shape[1:], dtype=src.dtype)
    return out.index_add_(0, seg, src)
def _pad(x, pw):
    flat = tuple(v for pair in reversed(pw) for v in pair)
    return torch.nn.functional.pad(x, flat)

kernel_name = 'concat_heads__mha_block_cached__gqa_block_cached__near_ridge'

def setup_inputs():

    _w = (lambda a: (lambda t: t.to(torch.bfloat16) if t.is_floating_point() else t)(torch.as_tensor(a)))
    def _A_setup():
        B, Sq, D = 8, 160, 576
        H, Sk, Dh = 32, 1024, 128
        return {
            "x": _w((lambda *s: torch.randn(*s, dtype=torch.bfloat16) * 0.8)(B, Sq, D)),
            "k_cache": _w((lambda *s: torch.randn(*s, dtype=torch.bfloat16) * 0.8)(B, H, Sk, Dh)),
            "v_cache": _w((lambda *s: torch.randn(*s, dtype=torch.bfloat16) * 0.05)(B, H, Sk, Dh)),
            "wq": _w((lambda *s: torch.randn(*s, dtype=torch.bfloat16) * 0.8)(D, H * Dh) * (D ** -0.5)),
            "wo": _w((lambda *s: torch.randn(*s, dtype=torch.bfloat16) * 0.05)(H * Dh, D) * ((H * Dh) ** -0.5)),
        }
    _A_in = _A_setup()

    def _B_setup():
        B, Sq, D = 8, 160, 576
        Hq, Hkv, Sk, Dh = 32, 32, 1024, 128
        assert Hq % Hkv == 0, (Hq, Hkv)
        return {
            "x": _w((lambda *s: torch.randn(*s, dtype=torch.bfloat16) * 0.8)(B, Sq, D)),
            "k_cache": _w((lambda *s: torch.randn(*s, dtype=torch.bfloat16) * 0.8)(B, Hkv, Sk, Dh)),
            "v_cache": _w((lambda *s: torch.randn(*s, dtype=torch.bfloat16) * 0.05)(B, Hkv, Sk, Dh)),
            "wq": _w((lambda *s: torch.randn(*s, dtype=torch.bfloat16) * 0.8)(D, Hq * Dh) * (D ** -0.5)),
            "wo": _w((lambda *s: torch.randn(*s, dtype=torch.bfloat16) * 0.05)(Hq * Dh, D) * ((Hq * Dh) ** -0.5)),
        }
    _B_in = _B_setup()

    return {
        "A_x": _A_in["x"],
        "A_k_cache": _A_in["k_cache"],
        "A_v_cache": _A_in["v_cache"],
        "A_wq": _A_in["wq"],
        "A_wo": _A_in["wo"],
        "B_x": _B_in["x"],
        "B_k_cache": _B_in["k_cache"],
        "B_v_cache": _B_in["v_cache"],
        "B_wq": _B_in["wq"],
        "B_wo": _B_in["wo"],
    }

def reference(A_x, A_k_cache, A_v_cache, A_wq, A_wo, B_x, B_k_cache, B_v_cache, B_wq, B_wo):
    def _A_ref(x, k_cache, v_cache, wq, wo):
        B, Sq, D = x.shape
        H, Dh = 32, 128
        q = (lambda x, *d: x.permute(*d))((x @ wq).reshape(B, Sq, H, Dh), 0, 2, 1, 3)
        scores = torch.einsum("bhqd,bhkd->bhqk", q, k_cache) * (Dh ** -0.5)
        p = _softmax(scores, axis=-1)
        o = torch.einsum("bhqk,bhkd->bhqd", p, v_cache)
        return (lambda x, *d: x.permute(*d))(o, 0, 2, 1, 3).reshape(B, Sq, H * Dh) @ wo

    def _B_ref(x, k_cache, v_cache, wq, wo):
        B, Sq, D = x.shape
        Hq, Dh = 32, 128
        Hkv = k_cache.shape[1]
        rep = Hq // Hkv
        q = (lambda x, *d: x.permute(*d))((x @ wq).reshape(B, Sq, Hq, Dh), 0, 2, 1, 3)
        k = (lambda x, n, axis: torch.repeat_interleave(x, n, dim=axis))(k_cache, rep, axis=1)
        v = (lambda x, n, axis: torch.repeat_interleave(x, n, dim=axis))(v_cache, rep, axis=1)
        scores = torch.einsum("bhqd,bhkd->bhqk", q, k) * (Dh ** -0.5)
        p = _softmax(scores, axis=-1)
        o = torch.einsum("bhqk,bhkd->bhqd", p, v)
        return (lambda x, *d: x.permute(*d))(o, 0, 2, 1, 3).reshape(B, Sq, Hq * Dh) @ wo

    a = _A_ref(A_x, A_k_cache, A_v_cache, A_wq, A_wo)
    b = _B_ref(B_x, B_k_cache, B_v_cache, B_wq, B_wo)
    return torch.concatenate([a, b], axis=-1)
```

```asm
; @launch grid=(256,1,1) block=(256,1,1) lds=163840
.amdgcn_target "amdgcn-amd-amdhsa--gfx950"
.text
.globl concat_heads__mha_block_cached__gqa_block_cached__near_ridge_kernel
.p2align 8
.type concat_heads__mha_block_cached__gqa_block_cached__near_ridge_kernel,@function
concat_heads__mha_block_cached__gqa_block_cached__near_ridge_kernel:
KERNEL_START:
  s_cmp_ge_u32 s2, 256
  s_cbranch_scc1 K1_END
  s_getpc_b64 s[76:77]
K1_pc:
  v_lshlrev_b32 v22, 7, v0
  s_sub_u32 s76, s76, K1_pc-KERNEL_START
  s_subb_u32 s77, s77, 0
  v_min_u32 v22, KERNEL_COLD_END-KERNEL_START, v22
  v_mov_b32 v23, s77
  v_add_co_u32 v22, vcc, s76, v22
  s_nop 1
  v_addc_co_u32 v23, vcc, 0, v23, vcc
  global_load_dword v19, v[22:23], off
  s_and_b32 s3, s2, 1
  s_mul_i32 s45, s3, 40
  s_add_u32 s0, s0, s45
  s_addc_u32 s1, s1, 0
  s_load_dwordx8 s[48:55], s[0:1], 0
  s_load_dwordx2 s[68:69], s[0:1], 32
  s_sub_u32 s0, s0, s45
  s_subb_u32 s1, s1, 0
  s_load_dwordx2 s[64:65], s[0:1], 96
  s_load_dwordx2 s[72:73], s[0:1], 80
  s_load_dwordx2 s[66:67], s[0:1], 88
  v_and_b32 v1, 63, v0
  v_lshrrev_b32 v2, 6, v0
  s_mov_b32 s25, s3
  s_bfe_u32 s3, s2, 0x20001
  v_readfirstlane_b32 s20, v2
  s_lshr_b32 s23, s2, 3
  s_lshr_b32 s24, s23, 3
  s_and_b32 s23, s23, 7
  s_lshl_b32 s3, s3, 3
  s_lshl_b32 s24, s24, 1
  s_add_u32 s24, s24, s3
  s_lshr_b32 s22, s20, 1
  s_and_b32 s21, s20, 1
  s_add_u32 s24, s24, s22
  s_mov_b32 s70, 0x3e0293ee
  s_mov_b32 s71, 0x3e0293ee
  v_and_b32 v26, 15, v1
  v_lshrrev_b32 v27, 4, v1
  v_lshlrev_b32 v16, 4, v1
  v_lshrrev_b32 v28, 2, v26
  v_and_b32 v29, 3, v1
  v_lshrrev_b32 v20, 2, v1
  v_lshrrev_b32 v21, 3, v20
  v_mul_u32_u24 v21, 3, v21
  v_xor_b32 v21, v29, v21
  v_lshlrev_b32 v21, 4, v21
  v_mul_u32_u24 v20, 1152, v20
  v_add_u32 v20, v20, v21
  s_mul_i32 s45, s20, 3
  s_min_u32 s45, s45, 7
  s_lshl_b32 s29, s45, 10
  s_add_u32 s29, s29, 16384
  s_mul_i32 s45, s45, 18432
  v_add_u32 v13, s45, v20
  v_add_u32 v14, 17408, v13
  v_add_u32 v15, 34816, v13
  v_lshlrev_b32 v21, 2, v27
  v_xor_b32 v21, v26, v21
  v_lshlrev_b32 v21, 4, v21
  v_lshlrev_b32 v22, 13, v27
  v_add_u32 v21, v21, v22
  s_lshl_b32 s45, s21, 17
  v_add_u32 v9, s45, v21
  v_add_u32 v10, 31744, v9
  v_add_u32 v11, 63488, v9
  v_add_u32 v12, 95232, v9
  s_lshl_b32 s28, s22, 13
  s_lshl_b32 s45, s21, 12
  s_add_u32 s28, s28, s45
  s_add_u32 s28, s28, 81920
  s_lshr_b32 s45, s2, 6
  s_mul_i32 s45, s45, 18
  s_mul_i32 s46, s23, 9
  s_add_u32 s45, s45, s46
  s_lshr_b32 s45, s45, 2
  s_cmp_ge_u32 s45, 18
  s_cselect_b32 s46, 18, 0
  s_sub_u32 s45, s45, s46
  s_lshl_b32 s27, s45, 6
  s_lshl_b32 s26, s45, 18
  s_waitcnt lgkmcnt(0)
  s_mul_i32 s45, s23, 184320
  s_add_u32 s8, s48, s45
  s_addc_u32 s9, s49, 0
  s_mov_b32 s10, 184320
  s_mov_b32 s11, 0x20000
  s_lshl_b32 s45, s24, 8
  s_add_u32 s4, s54, s45
  s_addc_u32 s5, s55, 0
  s_sub_u32 s6, 4718592, s45
  s_mov_b32 s7, 0x20000
  s_add_u32 m0, s28, 32768
  s_nop 0
  buffer_load_dwordx4 v9, s[4:7], s26 offen offset:0  lds
  buffer_load_dwordx4 v10, s[4:7], s26 offen offset:1024  lds
  buffer_load_dwordx4 v11, s[4:7], s26 offen offset:2048  lds
  buffer_load_dwordx4 v12, s[4:7], s26 offen offset:3072  lds
  s_add_u32 m0, s29, 32768
  s_add_u32 s26, s26, 262144
  buffer_load_dwordx4 v13, s[8:11], s27 offen offset:0  lds
  buffer_load_dwordx4 v14, s[8:11], s27 offen offset:1024  lds
  buffer_load_dwordx4 v15, s[8:11], s27 offen offset:2048  lds
  s_add_u32 s27, s27, 64
  s_cmp_eq_u32 s27, 1152
  s_cselect_b32 s27, 0, s27
  s_cselect_b32 s26, 0, s26
  s_add_u32 m0, s28, 49152
  s_nop 0
  buffer_load_dwordx4 v9, s[4:7], s26 offen offset:0  lds
  buffer_load_dwordx4 v10, s[4:7], s26 offen offset:1024  lds
  buffer_load_dwordx4 v11, s[4:7], s26 offen offset:2048  lds
  buffer_load_dwordx4 v12, s[4:7], s26 offen offset:3072  lds
  s_add_u32 m0, s29, 131072
  s_add_u32 s26, s26, 262144
  buffer_load_dwordx4 v13, s[8:11], s27 offen offset:0  lds
  buffer_load_dwordx4 v14, s[8:11], s27 offen offset:1024  lds
  buffer_load_dwordx4 v15, s[8:11], s27 offen offset:2048  lds
  s_add_u32 s27, s27, 64
  s_cmp_eq_u32 s27, 1152
  s_cselect_b32 s27, 0, s27
  s_cselect_b32 s26, 0, s26
  s_lshr_b32 s30, s2, 6
  s_bfe_u32 s31, s2, 0x20001
  s_lshl_b32 s32, s25, 3
  s_add_u32 s32, s32, s23
  s_lshl_b32 s32, s32, 2
  s_add_u32 s33, s32, s30
  s_add_u32 s32, s32, s31
  s_add_u32 s56, s64, 25165824
  s_addc_u32 s57, s65, 0
  s_mov_b32 s58, 32768
  s_mov_b32 s59, 0x20000
  s_mov_b32 s60, s66
  s_mov_b32 s61, s67
  s_mov_b32 s62, 256
  s_mov_b32 s63, 0x20000
  s_cmp_lg_u32 s20, 0
  s_cbranch_scc1 IZ_done
  v_lshlrev_b32 v20, 2, v1
  v_mov_b32 v21, 0
  s_cmp_lg_u32 s30, 0
  s_cbranch_scc1 IZ_g
  s_lshl_b32 s45, s32, 8
  buffer_store_dword v21, v20, s[56:59], s45 offen sc1
IZ_g:
  s_cmp_lg_u32 s31, 0
  s_cbranch_scc1 IZ_done
  s_add_u32 s45, s33, 64
  s_lshl_b32 s45, s45, 8
  buffer_store_dword v21, v20, s[56:59], s45 offen sc1
IZ_done:
  s_cmp_eq_u32 s21, 0
  s_cbranch_scc1 K1_myK
  v_add_u32 v22, 0, v27
  v_lshlrev_b32 v22, 1, v22
  v_xor_b32 v22, v26, v22
  v_lshlrev_b32 v22, 4, v22
  v_lshl_add_u32 v48, v27, 8, v22
  v_mov_b32 v50, v48
  v_add_u32 v22, 4, v27
  v_lshlrev_b32 v22, 1, v22
  v_xor_b32 v22, v26, v22
  v_lshlrev_b32 v22, 4, v22
  v_lshl_add_u32 v49, v27, 8, v22
  v_mov_b32 v51, v49
  s_branch K1_myD
K1_myK:
  v_add_u32 v22, 0, v27
  v_xor_b32 v22, v26, v22
  v_lshlrev_b32 v22, 4, v22
  v_lshl_add_u32 v48, v27, 8, v22
  v_add_u32 v22, 4, v27
  v_xor_b32 v22, v26, v22
  v_lshlrev_b32 v22, 4, v22
  v_lshl_add_u32 v49, v27, 8, v22
  v_add_u32 v22, 8, v27
  v_xor_b32 v22, v26, v22
  v_lshlrev_b32 v22, 4, v22
  v_lshl_add_u32 v50, v27, 8, v22
  v_add_u32 v22, 12, v27
  v_xor_b32 v22, v26, v22
  v_lshlrev_b32 v22, 4, v22
  v_lshl_add_u32 v51, v27, 8, v22
K1_myD:
  s_lshl_b32 s45, s23, 5
  s_add_u32 s45, s45, s24
  s_lshr_b32 s46, s45, 14
  s_lshl_b32 s45, s45, 18
  s_cmp_eq_u32 s21, 0
  s_cselect_b32 s12, s50, s52
  s_cselect_b32 s13, s51, s53
  s_add_u32 s12, s12, s45
  s_addc_u32 s13, s13, s46
  s_mov_b32 s14, 262144
  s_mov_b32 s15, 0x20000
  s_mov_b32 s36, 0
  s_mul_i32 s39, s21, 65536
  s_lshl_b32 s45, s22, 13
  s_add_u32 s39, s39, s45
  v_xor_b32 v22, v27, v26
  v_lshlrev_b32 v23, 8, v26
  v_add_u32 v23, s45, v23
  v_xor_b32 v24, 0, v22
  v_lshl_add_u32 v36, v24, 4, v23
  v_xor_b32 v24, 4, v22
  v_lshl_add_u32 v37, v24, 4, v23
  v_xor_b32 v24, 8, v22
  v_lshl_add_u32 v38, v24, 4, v23
  v_xor_b32 v24, 12, v22
  v_lshl_add_u32 v39, v24, 4, v23
  v_lshl_add_u32 v22, v27, 2, v28
  v_lshlrev_b32 v23, 8, v22
  v_lshl_add_u32 v23, v29, 3, v23
  s_add_u32 s46, s45, 65536
  v_add_u32 v23, s46, v23
  v_and_b32 v22, 7, v22
  v_xor_b32 v24, 0, v22
  v_lshl_add_u32 v40, v24, 5, v23
  v_xor_b32 v24, 1, v22
  v_lshl_add_u32 v41, v24, 5, v23
  v_xor_b32 v24, 2, v22
  v_lshl_add_u32 v42, v24, 5, v23
  v_xor_b32 v24, 3, v22
  v_lshl_add_u32 v43, v24, 5, v23
  v_xor_b32 v24, 4, v22
  v_lshl_add_u32 v44, v24, 5, v23
  v_xor_b32 v24, 5, v22
  v_lshl_add_u32 v45, v24, 5, v23
  v_xor_b32 v24, 6, v22
  v_lshl_add_u32 v46, v24, 5, v23
  v_xor_b32 v24, 7, v22
  v_lshl_add_u32 v47, v24, 5, v23
  v_lshrrev_b32 v22, 3, v26
  v_mul_u32_u24 v22, 3, v22
  v_xor_b32 v22, v27, v22
  v_lshlrev_b32 v22, 4, v22
  v_lshl_add_u32 v22, v26, 6, v22
  s_mul_i32 s46, s21, 5120
  s_add_u32 s46, s46, 16384
  v_add_u32 v4, s46, v22
  v_add_u32 v3, 131072, v4
  v_lshl_add_u32 v22, v27, 3, v28
  v_lshlrev_b32 v22, 8, v22
  v_lshl_add_u32 v22, v29, 4, v22
  s_add_u32 s46, s45, 81920
  v_add_u32 v22, s46, v22
  v_xor_b32 v23, 0, v28
  v_lshl_add_u32 v5, v23, 6, v22
  v_xor_b32 v23, 1, v28
  v_lshl_add_u32 v6, v23, 6, v22
  v_xor_b32 v23, 2, v28
  v_lshl_add_u32 v7, v23, 6, v22
  v_xor_b32 v23, 3, v28
  v_lshl_add_u32 v8, v23, 6, v22
  v_mov_b32 v22, 0x3f803f80
  v_mov_b32 v23, 0
  v_accvgpr_write_b32 a228, v22
  v_accvgpr_write_b32 a232, v23
  v_accvgpr_write_b32 a229, v22
  v_accvgpr_write_b32 a233, v23
  v_accvgpr_write_b32 a230, v22
  v_accvgpr_write_b32 a234, v23
  v_accvgpr_write_b32 a231, v22
  v_accvgpr_write_b32 a235, v23
  v_mov_b32 v52, 0
  v_mov_b32 v53, 0
  v_mov_b32 v54, 0
  v_mov_b32 v55, 0
  v_mov_b32 v56, 0
  v_mov_b32 v57, 0
  v_mov_b32 v58, 0
  v_mov_b32 v59, 0
  v_mov_b32 v60, 0
  v_mov_b32 v61, 0
  v_mov_b32 v62, 0
  v_mov_b32 v63, 0
  v_mov_b32 v64, 0
  v_mov_b32 v65, 0
  v_mov_b32 v66, 0
  v_mov_b32 v67, 0
  v_mov_b32 v68, 0
  v_mov_b32 v69, 0
  v_mov_b32 v70, 0
  v_mov_b32 v71, 0
  s_lshl_b32 s45, s25, 3
  s_add_u32 s45, s45, s23
  s_lshl_b32 s45, s45, 2
  s_lshr_b32 s46, s24, 3
  s_add_u32 s45, s45, s46
  s_mul_i32 s45, s45, 327680
  s_and_b32 s46, s24, 7
  s_mul_i32 s46, s46, 40960
  s_add_u32 s45, s45, s46
  s_mul_i32 s46, s21, 5120
  s_add_u32 s45, s45, s46
  s_add_u32 s16, s64, s45
  s_addc_u32 s17, s65, 0
  s_mov_b32 s18, 35840
  s_mov_b32 s19, 0x20000
  s_mul_i32 s45, s31, 1179648
  s_add_u32 s48, s68, s45
  s_addc_u32 s49, s69, 0
  s_mov_b32 s50, 1179648
  s_mov_b32 s51, 0x20000
  s_lshr_b32 s45, s2, 3
  s_lshl_b32 s45, s45, 2
  s_add_u32 s45, s45, s20
  s_mul_i32 s45, s45, 72
  v_add_u32 v17, s45, v1
  v_lshlrev_b32 v17, 7, v17
  v_add_u32 v18, 8192, v17
  v_cmp_gt_u32 vcc, 8, v1
  v_mov_b32 v22, 0x80000000
  s_nop 1
  v_cndmask_b32 v18, v22, v18, vcc
  v_mfma_f32_32x32x16_bf16 v[96:111], a[232:235], a[232:235], 0
  v_mfma_f32_32x32x16_bf16 v[112:127], a[232:235], a[232:235], 0
  v_mfma_f32_32x32x16_bf16 v[128:143], a[232:235], a[232:235], 0
  v_mfma_f32_32x32x16_bf16 v[144:159], a[232:235], a[232:235], 0
  v_mfma_f32_32x32x16_bf16 v[160:175], a[232:235], a[232:235], 0
  v_mfma_f32_32x32x16_bf16 v[176:191], a[232:235], a[232:235], 0
  v_mfma_f32_32x32x16_bf16 v[192:207], a[232:235], a[232:235], 0
  v_mfma_f32_32x32x16_bf16 v[208:223], a[232:235], a[232:235], 0
  v_mfma_f32_32x32x16_bf16 v[224:239], a[232:235], a[232:235], 0
  v_mfma_f32_32x32x16_bf16 v[240:255], a[232:235], a[232:235], 0
  s_waitcnt vmcnt(7)
  s_barrier
  ds_read_b128 a[80:83], v4 offset:32768
  ds_read_b128 a[84:87], v4 offset:33792
  ds_read_b128 a[88:91], v4 offset:34816
  ds_read_b128 a[92:95], v4 offset:35840
  ds_read_b128 a[96:99], v4 offset:36864
  ds_read_b64_tr_b16 a[120:121], v5 offset:32768
  ds_read_b64_tr_b16 a[122:123], v5 offset:33792
  ds_read_b64_tr_b16 a[124:125], v5 offset:32776
  ds_read_b64_tr_b16 a[126:127], v5 offset:33800
  ds_read_b64_tr_b16 a[128:129], v6 offset:32768
  ds_read_b64_tr_b16 a[130:131], v6 offset:33792
  ds_read_b64_tr_b16 a[132:133], v6 offset:32776
  ds_read_b64_tr_b16 a[134:135], v6 offset:33800
  ds_read_b64_tr_b16 a[136:137], v7 offset:32768
  ds_read_b64_tr_b16 a[138:139], v7 offset:33792
  ds_read_b64_tr_b16 a[140:141], v7 offset:32776
  ds_read_b64_tr_b16 a[142:143], v7 offset:33800
  ds_read_b64_tr_b16 a[144:145], v8 offset:32768
  ds_read_b64_tr_b16 a[146:147], v8 offset:33792
  ds_read_b64_tr_b16 a[148:149], v8 offset:32776
  ds_read_b64_tr_b16 a[150:151], v8 offset:33800
  s_add_u32 m0, s28, 0
  s_nop 0
  buffer_load_dwordx4 v9, s[4:7], s26 offen offset:0  lds
  buffer_load_dwordx4 v10, s[4:7], s26 offen offset:1024  lds
  buffer_load_dwordx4 v11, s[4:7], s26 offen offset:2048  lds
  buffer_load_dwordx4 v12, s[4:7], s26 offen offset:3072  lds
  s_add_u32 m0, s29, 0
  s_add_u32 s26, s26, 262144
  buffer_load_dwordx4 v13, s[8:11], s27 offen offset:0  lds
  buffer_load_dwordx4 v14, s[8:11], s27 offen offset:1024  lds
  buffer_load_dwordx4 v15, s[8:11], s27 offen offset:2048  lds
  s_add_u32 s27, s27, 64
  s_cmp_eq_u32 s27, 1152
  s_cselect_b32 s27, 0, s27
  s_cselect_b32 s26, 0, s26
  s_add_u32 m0, s28, 16384
  s_nop 0
  buffer_load_dwordx4 v9, s[4:7], s26 offen offset:0  lds
  buffer_load_dwordx4 v10, s[4:7], s26 offen offset:1024  lds
  buffer_load_dwordx4 v11, s[4:7], s26 offen offset:2048  lds
  buffer_load_dwordx4 v12, s[4:7], s26 offen offset:3072  lds
  s_add_u32 m0, s29, 16384
  s_add_u32 s26, s26, 262144
  buffer_load_dwordx4 v13, s[8:11], s27 offen offset:0  lds
  buffer_load_dwordx4 v14, s[8:11], s27 offen offset:1024  lds
  buffer_load_dwordx4 v15, s[8:11], s27 offen offset:2048  lds
  s_add_u32 s27, s27, 64
  s_cmp_eq_u32 s27, 1152
  s_cselect_b32 s27, 0, s27
  s_cselect_b32 s26, 0, s26
  s_add_u32 m0, s39, 0
  s_nop 0
  buffer_load_dwordx4 v48, s[12:15], s36 offen offset:0 nt lds
  buffer_load_dwordx4 v49, s[12:15], s36 offen offset:1024 nt lds
  buffer_load_dwordx4 v50, s[12:15], s36 offen offset:2048 nt lds
  buffer_load_dwordx4 v51, s[12:15], s36 offen offset:3072 nt lds
  s_add_u32 s36, s36, 4096
  s_add_u32 m0, s39, 4096
  s_nop 0
  buffer_load_dwordx4 v48, s[12:15], s36 offen offset:0 nt lds
  buffer_load_dwordx4 v49, s[12:15], s36 offen offset:1024 nt lds
  buffer_load_dwordx4 v50, s[12:15], s36 offen offset:2048 nt lds
  buffer_load_dwordx4 v51, s[12:15], s36 offen offset:3072 nt lds
  s_add_u32 s36, s36, 4096
  s_waitcnt vmcnt(22) lgkmcnt(0)
  s_barrier
  s_mov_b32 s40, 0
.p2align 4
Q_loop:
  v_mfma_f32_16x16x32_bf16 v[96:99], a[120:123], a[80:83], v[96:99]
  s_add_u32 m0, s28, 32768
  v_mfma_f32_16x16x32_bf16 v[100:103], a[120:123], a[84:87], v[100:103]
  ds_read_b128 a[100:103], v3 offset:0
  v_mfma_f32_16x16x32_bf16 v[104:107], a[120:123], a[88:91], v[104:107]
  ds_read_b128 a[104:107], v3 offset:1024
  v_mfma_f32_16x16x32_bf16 v[108:111], a[120:123], a[92:95], v[108:111]
  buffer_load_dwordx4 v9, s[4:7], s26 offen offset:0  lds
  v_mfma_f32_16x16x32_bf16 v[112:115], a[120:123], a[96:99], v[112:115]
  ds_read_b128 a[108:111], v3 offset:2048
  v_mfma_f32_16x16x32_bf16 v[116:119], a[124:127], a[80:83], v[116:119]
  ds_read_b128 a[112:115], v3 offset:3072
  v_mfma_f32_16x16x32_bf16 v[120:123], a[124:127], a[84:87], v[120:123]
  ds_read_b128 a[116:119], v3 offset:4096
  v_mfma_f32_16x16x32_bf16 v[124:127], a[124:127], a[88:91], v[124:127]
  ds_read_b64_tr_b16 a[152:153], v5 offset:49152
  v_mfma_f32_16x16x32_bf16 v[128:131], a[124:127], a[92:95], v[128:131]
  buffer_load_dwordx4 v10, s[4:7], s26 offen offset:1024  lds
  v_mfma_f32_16x16x32_bf16 v[132:135], a[124:127], a[96:99], v[132:135]
  ds_read_b64_tr_b16 a[154:155], v5 offset:50176
  v_mfma_f32_16x16x32_bf16 v[136:139], a[128:131], a[80:83], v[136:139]
  ds_read_b64_tr_b16 a[156:157], v5 offset:49160
  v_mfma_f32_16x16x32_bf16 v[140:143], a[128:131], a[84:87], v[140:143]
  ds_read_b64_tr_b16 a[158:159], v5 offset:50184
  v_mfma_f32_16x16x32_bf16 v[144:147], a[128:131], a[88:91], v[144:147]
  ds_read_b64_tr_b16 a[160:161], v6 offset:49152
  v_mfma_f32_16x16x32_bf16 v[148:151], a[128:131], a[92:95], v[148:151]
  buffer_load_dwordx4 v11, s[4:7], s26 offen offset:2048  lds
  v_mfma_f32_16x16x32_bf16 v[152:155], a[128:131], a[96:99], v[152:155]
  ds_read_b64_tr_b16 a[162:163], v6 offset:50176
  v_mfma_f32_16x16x32_bf16 v[156:159], a[132:135], a[80:83], v[156:159]
  ds_read_b64_tr_b16 a[164:165], v6 offset:49160
  v_mfma_f32_16x16x32_bf16 v[160:163], a[132:135], a[84:87], v[160:163]
  ds_read_b64_tr_b16 a[166:167], v6 offset:50184
  v_mfma_f32_16x16x32_bf16 v[164:167], a[132:135], a[88:91], v[164:167]
  ds_read_b64_tr_b16 a[168:169], v7 offset:49152
  v_mfma_f32_16x16x32_bf16 v[168:171], a[132:135], a[92:95], v[168:171]
  buffer_load_dwordx4 v12, s[4:7], s26 offen offset:3072  lds
  s_add_u32 m0, s29, 32768
  v_mfma_f32_16x16x32_bf16 v[172:175], a[132:135], a[96:99], v[172:175]
  ds_read_b64_tr_b16 a[170:171], v7 offset:50176
  v_mfma_f32_16x16x32_bf16 v[176:179], a[136:139], a[80:83], v[176:179]
  ds_read_b64_tr_b16 a[172:173], v7 offset:49160
  v_mfma_f32_16x16x32_bf16 v[180:183], a[136:139], a[84:87], v[180:183]
  ds_read_b64_tr_b16 a[174:175], v7 offset:50184
  v_mfma_f32_16x16x32_bf16 v[184:187], a[136:139], a[88:91], v[184:187]
  ds_read_b64_tr_b16 a[176:177], v8 offset:49152
  v_mfma_f32_16x16x32_bf16 v[188:191], a[136:139], a[92:95], v[188:191]
  s_add_u32 s26, s26, 262144
  buffer_load_dwordx4 v13, s[8:11], s27 offen offset:0  lds
  v_mfma_f32_16x16x32_bf16 v[192:195], a[136:139], a[96:99], v[192:195]
  ds_read_b64_tr_b16 a[178:179], v8 offset:50176
  v_mfma_f32_16x16x32_bf16 v[196:199], a[140:143], a[80:83], v[196:199]
  ds_read_b64_tr_b16 a[180:181], v8 offset:49160
  v_mfma_f32_16x16x32_bf16 v[200:203], a[140:143], a[84:87], v[200:203]
  ds_read_b64_tr_b16 a[182:183], v8 offset:50184
  v_mfma_f32_16x16x32_bf16 v[204:207], a[140:143], a[88:91], v[204:207]
  v_mfma_f32_16x16x32_bf16 v[208:211], a[140:143], a[92:95], v[208:211]
  buffer_load_dwordx4 v14, s[8:11], s27 offen offset:1024  lds
  v_mfma_f32_16x16x32_bf16 v[212:215], a[140:143], a[96:99], v[212:215]
  v_mfma_f32_16x16x32_bf16 v[216:219], a[144:147], a[80:83], v[216:219]
  v_mfma_f32_16x16x32_bf16 v[220:223], a[144:147], a[84:87], v[220:223]
  v_mfma_f32_16x16x32_bf16 v[224:227], a[144:147], a[88:91], v[224:227]
  v_mfma_f32_16x16x32_bf16 v[228:231], a[144:147], a[92:95], v[228:231]
  buffer_load_dwordx4 v15, s[8:11], s27 offen offset:2048  lds
  s_add_u32 s27, s27, 64
  v_mfma_f32_16x16x32_bf16 v[232:235], a[144:147], a[96:99], v[232:235]
  v_mfma_f32_16x16x32_bf16 v[236:239], a[148:151], a[80:83], v[236:239]
  s_cmp_eq_u32 s27, 1152
  v_mfma_f32_16x16x32_bf16 v[240:243], a[148:151], a[84:87], v[240:243]
  s_cselect_b32 s27, 0, s27
  v_mfma_f32_16x16x32_bf16 v[244:247], a[148:151], a[88:91], v[244:247]
  s_cselect_b32 s26, 0, s26
  v_mfma_f32_16x16x32_bf16 v[248:251], a[148:151], a[92:95], v[248:251]
  v_mfma_f32_16x16x32_bf16 v[252:255], a[148:151], a[96:99], v[252:255]
  s_waitcnt vmcnt(14) lgkmcnt(0)
  s_barrier
  v_mfma_f32_16x16x32_bf16 v[96:99], a[152:155], a[100:103], v[96:99]
  s_add_u32 m0, s28, 49152
  v_mfma_f32_16x16x32_bf16 v[100:103], a[152:155], a[104:107], v[100:103]
  ds_read_b128 a[80:83], v4 offset:0
  v_mfma_f32_16x16x32_bf16 v[104:107], a[152:155], a[108:111], v[104:107]
  ds_read_b128 a[84:87], v4 offset:1024
  v_mfma_f32_16x16x32_bf16 v[108:111], a[152:155], a[112:115], v[108:111]
  buffer_load_dwordx4 v9, s[4:7], s26 offen offset:0  lds
  v_mfma_f32_16x16x32_bf16 v[112:115], a[152:155], a[116:119], v[112:115]
  ds_read_b128 a[88:91], v4 offset:2048
  v_mfma_f32_16x16x32_bf16 v[116:119], a[156:159], a[100:103], v[116:119]
  ds_read_b128 a[92:95], v4 offset:3072
  v_mfma_f32_16x16x32_bf16 v[120:123], a[156:159], a[104:107], v[120:123]
  ds_read_b128 a[96:99], v4 offset:4096
  v_mfma_f32_16x16x32_bf16 v[124:127], a[156:159], a[108:111], v[124:127]
  ds_read_b64_tr_b16 a[120:121], v5 offset:0
  v_mfma_f32_16x16x32_bf16 v[128:131], a[156:159], a[112:115], v[128:131]
  buffer_load_dwordx4 v10, s[4:7], s26 offen offset:1024  lds
  v_mfma_f32_16x16x32_bf16 v[132:135], a[156:159], a[116:119], v[132:135]
  ds_read_b64_tr_b16 a[122:123], v5 offset:1024
  v_mfma_f32_16x16x32_bf16 v[136:139], a[160:163], a[100:103], v[136:139]
  ds_read_b64_tr_b16 a[124:125], v5 offset:8
  v_mfma_f32_16x16x32_bf16 v[140:143], a[160:163], a[104:107], v[140:143]
  ds_read_b64_tr_b16 a[126:127], v5 offset:1032
  v_mfma_f32_16x16x32_bf16 v[144:147], a[160:163], a[108:111], v[144:147]
  ds_read_b64_tr_b16 a[128:129], v6 offset:0
  v_mfma_f32_16x16x32_bf16 v[148:151], a[160:163], a[112:115], v[148:151]
  buffer_load_dwordx4 v11, s[4:7], s26 offen offset:2048  lds
  v_mfma_f32_16x16x32_bf16 v[152:155], a[160:163], a[116:119], v[152:155]
  ds_read_b64_tr_b16 a[130:131], v6 offset:1024
  v_mfma_f32_16x16x32_bf16 v[156:159], a[164:167], a[100:103], v[156:159]
  ds_read_b64_tr_b16 a[132:133], v6 offset:8
  v_mfma_f32_16x16x32_bf16 v[160:163], a[164:167], a[104:107], v[160:163]
  ds_read_b64_tr_b16 a[134:135], v6 offset:1032
  v_mfma_f32_16x16x32_bf16 v[164:167], a[164:167], a[108:111], v[164:167]
  ds_read_b64_tr_b16 a[136:137], v7 offset:0
  v_mfma_f32_16x16x32_bf16 v[168:171], a[164:167], a[112:115], v[168:171]
  buffer_load_dwordx4 v12, s[4:7], s26 offen offset:3072  lds
  s_add_u32 m0, s29, 131072
  v_mfma_f32_16x16x32_bf16 v[172:175], a[164:167], a[116:119], v[172:175]
  ds_read_b64_tr_b16 a[138:139], v7 offset:1024
  v_mfma_f32_16x16x32_bf16 v[176:179], a[168:171], a[100:103], v[176:179]
  ds_read_b64_tr_b16 a[140:141], v7 offset:8
  v_mfma_f32_16x16x32_bf16 v[180:183], a[168:171], a[104:107], v[180:183]
  ds_read_b64_tr_b16 a[142:143], v7 offset:1032
  v_mfma_f32_16x16x32_bf16 v[184:187], a[168:171], a[108:111], v[184:187]
  ds_read_b64_tr_b16 a[144:145], v8 offset:0
  v_mfma_f32_16x16x32_bf16 v[188:191], a[168:171], a[112:115], v[188:191]
  s_add_u32 s26, s26, 262144
  buffer_load_dwordx4 v13, s[8:11], s27 offen offset:0  lds
  v_mfma_f32_16x16x32_bf16 v[192:195], a[168:171], a[116:119], v[192:195]
  ds_read_b64_tr_b16 a[146:147], v8 offset:1024
  v_mfma_f32_16x16x32_bf16 v[196:199], a[172:175], a[100:103], v[196:199]
  ds_read_b64_tr_b16 a[148:149], v8 offset:8
  v_mfma_f32_16x16x32_bf16 v[200:203], a[172:175], a[104:107], v[200:203]
  ds_read_b64_tr_b16 a[150:151], v8 offset:1032
  v_mfma_f32_16x16x32_bf16 v[204:207], a[172:175], a[108:111], v[204:207]
  v_mfma_f32_16x16x32_bf16 v[208:211], a[172:175], a[112:115], v[208:211]
  buffer_load_dwordx4 v14, s[8:11], s27 offen offset:1024  lds
  v_mfma_f32_16x16x32_bf16 v[212:215], a[172:175], a[116:119], v[212:215]
  v_mfma_f32_16x16x32_bf16 v[216:219], a[176:179], a[100:103], v[216:219]
  v_mfma_f32_16x16x32_bf16 v[220:223], a[176:179], a[104:107], v[220:223]
  v_mfma_f32_16x16x32_bf16 v[224:227], a[176:179], a[108:111], v[224:227]
  v_mfma_f32_16x16x32_bf16 v[228:231], a[176:179], a[112:115], v[228:231]
  buffer_load_dwordx4 v15, s[8:11], s27 offen offset:2048  lds
  s_add_u32 s27, s27, 64
  v_mfma_f32_16x16x32_bf16 v[232:235], a[176:179], a[116:119], v[232:235]
  v_mfma_f32_16x16x32_bf16 v[236:239], a[180:183], a[100:103], v[236:239]
  s_cmp_eq_u32 s27, 1152
  v_mfma_f32_16x16x32_bf16 v[240:243], a[180:183], a[104:107], v[240:243]
  s_cselect_b32 s27, 0, s27
  v_mfma_f32_16x16x32_bf16 v[244:247], a[180:183], a[108:111], v[244:247]
  s_cselect_b32 s26, 0, s26
  v_mfma_f32_16x16x32_bf16 v[248:251], a[180:183], a[112:115], v[248:251]
  v_mfma_f32_16x16x32_bf16 v[252:255], a[180:183], a[116:119], v[252:255]
  s_waitcnt vmcnt(14) lgkmcnt(0)
  s_barrier
  v_mfma_f32_16x16x32_bf16 v[96:99], a[120:123], a[80:83], v[96:99]
  s_add_u32 m0, s28, 0
  v_mfma_f32_16x16x32_bf16 v[100:103], a[120:123], a[84:87], v[100:103]
  ds_read_b128 a[100:103], v4 offset:16384
  v_mfma_f32_16x16x32_bf16 v[104:107], a[120:123], a[88:91], v[104:107]
  ds_read_b128 a[104:107], v4 offset:17408
  v_mfma_f32_16x16x32_bf16 v[108:111], a[120:123], a[92:95], v[108:111]
  buffer_load_dwordx4 v9, s[4:7], s26 offen offset:0  lds
  v_mfma_f32_16x16x32_bf16 v[112:115], a[120:123], a[96:99], v[112:115]
  ds_read_b128 a[108:111], v4 offset:18432
  v_mfma_f32_16x16x32_bf16 v[116:119], a[124:127], a[80:83], v[116:119]
  ds_read_b128 a[112:115], v4 offset:19456
  v_mfma_f32_16x16x32_bf16 v[120:123], a[124:127], a[84:87], v[120:123]
  ds_read_b128 a[116:119], v4 offset:20480
  v_mfma_f32_16x16x32_bf16 v[124:127], a[124:127], a[88:91], v[124:127]
  ds_read_b64_tr_b16 a[152:153], v5 offset:16384
  v_mfma_f32_16x16x32_bf16 v[128:131], a[124:127], a[92:95], v[128:131]
  buffer_load_dwordx4 v10, s[4:7], s26 offen offset:1024  lds
  v_mfma_f32_16x16x32_bf16 v[132:135], a[124:127], a[96:99], v[132:135]
  ds_read_b64_tr_b16 a[154:155], v5 offset:17408
  v_mfma_f32_16x16x32_bf16 v[136:139], a[128:131], a[80:83], v[136:139]
  ds_read_b64_tr_b16 a[156:157], v5 offset:16392
  v_mfma_f32_16x16x32_bf16 v[140:143], a[128:131], a[84:87], v[140:143]
  ds_read_b64_tr_b16 a[158:159], v5 offset:17416
  v_mfma_f32_16x16x32_bf16 v[144:147], a[128:131], a[88:91], v[144:147]
  ds_read_b64_tr_b16 a[160:161], v6 offset:16384
  v_mfma_f32_16x16x32_bf16 v[148:151], a[128:131], a[92:95], v[148:151]
  buffer_load_dwordx4 v11, s[4:7], s26 offen offset:2048  lds
  v_mfma_f32_16x16x32_bf16 v[152:155], a[128:131], a[96:99], v[152:155]
  ds_read_b64_tr_b16 a[162:163], v6 offset:17408
  v_mfma_f32_16x16x32_bf16 v[156:159], a[132:135], a[80:83], v[156:159]
  ds_read_b64_tr_b16 a[164:165], v6 offset:16392
  v_mfma_f32_16x16x32_bf16 v[160:163], a[132:135], a[84:87], v[160:163]
  ds_read_b64_tr_b16 a[166:167], v6 offset:17416
  v_mfma_f32_16x16x32_bf16 v[164:167], a[132:135], a[88:91], v[164:167]
  ds_read_b64_tr_b16 a[168:169], v7 offset:16384
  v_mfma_f32_16x16x32_bf16 v[168:171], a[132:135], a[92:95], v[168:171]
  buffer_load_dwordx4 v12, s[4:7], s26 offen offset:3072  lds
  s_add_u32 m0, s29, 0
  v_mfma_f32_16x16x32_bf16 v[172:175], a[132:135], a[96:99], v[172:175]
  ds_read_b64_tr_b16 a[170:171], v7 offset:17408
  v_mfma_f32_16x16x32_bf16 v[176:179], a[136:139], a[80:83], v[176:179]
  ds_read_b64_tr_b16 a[172:173], v7 offset:16392
  v_mfma_f32_16x16x32_bf16 v[180:183], a[136:139], a[84:87], v[180:183]
  ds_read_b64_tr_b16 a[174:175], v7 offset:17416
  v_mfma_f32_16x16x32_bf16 v[184:187], a[136:139], a[88:91], v[184:187]
  ds_read_b64_tr_b16 a[176:177], v8 offset:16384
  v_mfma_f32_16x16x32_bf16 v[188:191], a[136:139], a[92:95], v[188:191]
  s_add_u32 s26, s26, 262144
  buffer_load_dwordx4 v13, s[8:11], s27 offen offset:0  lds
  v_mfma_f32_16x16x32_bf16 v[192:195], a[136:139], a[96:99], v[192:195]
  ds_read_b64_tr_b16 a[178:179], v8 offset:17408
  v_mfma_f32_16x16x32_bf16 v[196:199], a[140:143], a[80:83], v[196:199]
  ds_read_b64_tr_b16 a[180:181], v8 offset:16392
  v_mfma_f32_16x16x32_bf16 v[200:203], a[140:143], a[84:87], v[200:203]
  ds_read_b64_tr_b16 a[182:183], v8 offset:17416
  v_mfma_f32_16x16x32_bf16 v[204:207], a[140:143], a[88:91], v[204:207]
  v_mfma_f32_16x16x32_bf16 v[208:211], a[140:143], a[92:95], v[208:211]
  buffer_load_dwordx4 v14, s[8:11], s27 offen offset:1024  lds
  v_mfma_f32_16x16x32_bf16 v[212:215], a[140:143], a[96:99], v[212:215]
  v_mfma_f32_16x16x32_bf16 v[216:219], a[144:147], a[80:83], v[216:219]
  v_mfma_f32_16x16x32_bf16 v[220:223], a[144:147], a[84:87], v[220:223]
  v_mfma_f32_16x16x32_bf16 v[224:227], a[144:147], a[88:91], v[224:227]
  v_mfma_f32_16x16x32_bf16 v[228:231], a[144:147], a[92:95], v[228:231]
  buffer_load_dwordx4 v15, s[8:11], s27 offen offset:2048  lds
  s_add_u32 s27, s27, 64
  v_mfma_f32_16x16x32_bf16 v[232:235], a[144:147], a[96:99], v[232:235]
  v_mfma_f32_16x16x32_bf16 v[236:239], a[148:151], a[80:83], v[236:239]
  s_cmp_eq_u32 s27, 1152
  v_mfma_f32_16x16x32_bf16 v[240:243], a[148:151], a[84:87], v[240:243]
  s_cselect_b32 s27, 0, s27
  v_mfma_f32_16x16x32_bf16 v[244:247], a[148:151], a[88:91], v[244:247]
  s_cselect_b32 s26, 0, s26
  v_mfma_f32_16x16x32_bf16 v[248:251], a[148:151], a[92:95], v[248:251]
  v_mfma_f32_16x16x32_bf16 v[252:255], a[148:151], a[96:99], v[252:255]
  s_waitcnt vmcnt(14) lgkmcnt(0)
  s_barrier
  v_mfma_f32_16x16x32_bf16 v[96:99], a[152:155], a[100:103], v[96:99]
  s_add_u32 m0, s28, 16384
  v_mfma_f32_16x16x32_bf16 v[100:103], a[152:155], a[104:107], v[100:103]
  ds_read_b128 a[80:83], v4 offset:32768
  v_mfma_f32_16x16x32_bf16 v[104:107], a[152:155], a[108:111], v[104:107]
  ds_read_b128 a[84:87], v4 offset:33792
  v_mfma_f32_16x16x32_bf16 v[108:111], a[152:155], a[112:115], v[108:111]
  buffer_load_dwordx4 v9, s[4:7], s26 offen offset:0  lds
  v_mfma_f32_16x16x32_bf16 v[112:115], a[152:155], a[116:119], v[112:115]
  ds_read_b128 a[88:91], v4 offset:34816
  v_mfma_f32_16x16x32_bf16 v[116:119], a[156:159], a[100:103], v[116:119]
  ds_read_b128 a[92:95], v4 offset:35840
  v_mfma_f32_16x16x32_bf16 v[120:123], a[156:159], a[104:107], v[120:123]
  ds_read_b128 a[96:99], v4 offset:36864
  v_mfma_f32_16x16x32_bf16 v[124:127], a[156:159], a[108:111], v[124:127]
  ds_read_b64_tr_b16 a[120:121], v5 offset:32768
  v_mfma_f32_16x16x32_bf16 v[128:131], a[156:159], a[112:115], v[128:131]
  buffer_load_dwordx4 v10, s[4:7], s26 offen offset:1024  lds
  v_mfma_f32_16x16x32_bf16 v[132:135], a[156:159], a[116:119], v[132:135]
  ds_read_b64_tr_b16 a[122:123], v5 offset:33792
  v_mfma_f32_16x16x32_bf16 v[136:139], a[160:163], a[100:103], v[136:139]
  ds_read_b64_tr_b16 a[124:125], v5 offset:32776
  v_mfma_f32_16x16x32_bf16 v[140:143], a[160:163], a[104:107], v[140:143]
  ds_read_b64_tr_b16 a[126:127], v5 offset:33800
  v_mfma_f32_16x16x32_bf16 v[144:147], a[160:163], a[108:111], v[144:147]
  ds_read_b64_tr_b16 a[128:129], v6 offset:32768
  v_mfma_f32_16x16x32_bf16 v[148:151], a[160:163], a[112:115], v[148:151]
  buffer_load_dwordx4 v11, s[4:7], s26 offen offset:2048  lds
  v_mfma_f32_16x16x32_bf16 v[152:155], a[160:163], a[116:119], v[152:155]
  ds_read_b64_tr_b16 a[130:131], v6 offset:33792
  v_mfma_f32_16x16x32_bf16 v[156:159], a[164:167], a[100:103], v[156:159]
  ds_read_b64_tr_b16 a[132:133], v6 offset:32776
  v_mfma_f32_16x16x32_bf16 v[160:163], a[164:167], a[104:107], v[160:163]
  ds_read_b64_tr_b16 a[134:135], v6 offset:33800
  v_mfma_f32_16x16x32_bf16 v[164:167], a[164:167], a[108:111], v[164:167]
  ds_read_b64_tr_b16 a[136:137], v7 offset:32768
  v_mfma_f32_16x16x32_bf16 v[168:171], a[164:167], a[112:115], v[168:171]
  buffer_load_dwordx4 v12, s[4:7], s26 offen offset:3072  lds
  s_add_u32 m0, s29, 16384
  v_mfma_f32_16x16x32_bf16 v[172:175], a[164:167], a[116:119], v[172:175]
  ds_read_b64_tr_b16 a[138:139], v7 offset:33792
  v_mfma_f32_16x16x32_bf16 v[176:179], a[168:171], a[100:103], v[176:179]
  ds_read_b64_tr_b16 a[140:141], v7 offset:32776
  v_mfma_f32_16x16x32_bf16 v[180:183], a[168:171], a[104:107], v[180:183]
  ds_read_b64_tr_b16 a[142:143], v7 offset:33800
  v_mfma_f32_16x16x32_bf16 v[184:187], a[168:171], a[108:111], v[184:187]
  ds_read_b64_tr_b16 a[144:145], v8 offset:32768
  v_mfma_f32_16x16x32_bf16 v[188:191], a[168:171], a[112:115], v[188:191]
  s_add_u32 s26, s26, 262144
  buffer_load_dwordx4 v13, s[8:11], s27 offen offset:0  lds
  v_mfma_f32_16x16x32_bf16 v[192:195], a[168:171], a[116:119], v[192:195]
  ds_read_b64_tr_b16 a[146:147], v8 offset:33792
  v_mfma_f32_16x16x32_bf16 v[196:199], a[172:175], a[100:103], v[196:199]
  ds_read_b64_tr_b16 a[148:149], v8 offset:32776
  v_mfma_f32_16x16x32_bf16 v[200:203], a[172:175], a[104:107], v[200:203]
  ds_read_b64_tr_b16 a[150:151], v8 offset:33800
  v_mfma_f32_16x16x32_bf16 v[204:207], a[172:175], a[108:111], v[204:207]
  v_mfma_f32_16x16x32_bf16 v[208:211], a[172:175], a[112:115], v[208:211]
  buffer_load_dwordx4 v14, s[8:11], s27 offen offset:1024  lds
  v_mfma_f32_16x16x32_bf16 v[212:215], a[172:175], a[116:119], v[212:215]
  v_mfma_f32_16x16x32_bf16 v[216:219], a[176:179], a[100:103], v[216:219]
  v_mfma_f32_16x16x32_bf16 v[220:223], a[176:179], a[104:107], v[220:223]
  v_mfma_f32_16x16x32_bf16 v[224:227], a[176:179], a[108:111], v[224:227]
  v_mfma_f32_16x16x32_bf16 v[228:231], a[176:179], a[112:115], v[228:231]
  buffer_load_dwordx4 v15, s[8:11], s27 offen offset:2048  lds
  s_add_u32 s27, s27, 64
  v_mfma_f32_16x16x32_bf16 v[232:235], a[176:179], a[116:119], v[232:235]
  v_mfma_f32_16x16x32_bf16 v[236:239], a[180:183], a[100:103], v[236:239]
  s_cmp_eq_u32 s27, 1152
  v_mfma_f32_16x16x32_bf16 v[240:243], a[180:183], a[104:107], v[240:243]
  s_cselect_b32 s27, 0, s27
  v_mfma_f32_16x16x32_bf16 v[244:247], a[180:183], a[108:111], v[244:247]
  s_cselect_b32 s26, 0, s26
  v_mfma_f32_16x16x32_bf16 v[248:251], a[180:183], a[112:115], v[248:251]
  v_mfma_f32_16x16x32_bf16 v[252:255], a[180:183], a[116:119], v[252:255]
  s_waitcnt vmcnt(14) lgkmcnt(0)
  s_add_u32 s40, s40, 1
  s_cmp_lt_u32 s40, 3
  s_barrier
  s_cbranch_scc1 Q_loop
  v_mfma_f32_16x16x32_bf16 v[96:99], a[120:123], a[80:83], v[96:99]
  s_add_u32 m0, s28, 32768
  v_mfma_f32_16x16x32_bf16 v[100:103], a[120:123], a[84:87], v[100:103]
  ds_read_b128 a[100:103], v3 offset:0
  v_mfma_f32_16x16x32_bf16 v[104:107], a[120:123], a[88:91], v[104:107]
  ds_read_b128 a[104:107], v3 offset:1024
  v_mfma_f32_16x16x32_bf16 v[108:111], a[120:123], a[92:95], v[108:111]
  buffer_load_dwordx4 v9, s[4:7], s26 offen offset:0  lds
  v_mfma_f32_16x16x32_bf16 v[112:115], a[120:123], a[96:99], v[112:115]
  ds_read_b128 a[108:111], v3 offset:2048
  v_mfma_f32_16x16x32_bf16 v[116:119], a[124:127], a[80:83], v[116:119]
  ds_read_b128 a[112:115], v3 offset:3072
  v_mfma_f32_16x16x32_bf16 v[120:123], a[124:127], a[84:87], v[120:123]
  ds_read_b128 a[116:119], v3 offset:4096
  v_mfma_f32_16x16x32_bf16 v[124:127], a[124:127], a[88:91], v[124:127]
  ds_read_b64_tr_b16 a[152:153], v5 offset:49152
  v_mfma_f32_16x16x32_bf16 v[128:131], a[124:127], a[92:95], v[128:131]
  buffer_load_dwordx4 v10, s[4:7], s26 offen offset:1024  lds
  v_mfma_f32_16x16x32_bf16 v[132:135], a[124:127], a[96:99], v[132:135]
  ds_read_b64_tr_b16 a[154:155], v5 offset:50176
  v_mfma_f32_16x16x32_bf16 v[136:139], a[128:131], a[80:83], v[136:139]
  ds_read_b64_tr_b16 a[156:157], v5 offset:49160
  v_mfma_f32_16x16x32_bf16 v[140:143], a[128:131], a[84:87], v[140:143]
  ds_read_b64_tr_b16 a[158:159], v5 offset:50184
  v_mfma_f32_16x16x32_bf16 v[144:147], a[128:131], a[88:91], v[144:147]
  ds_read_b64_tr_b16 a[160:161], v6 offset:49152
  v_mfma_f32_16x16x32_bf16 v[148:151], a[128:131], a[92:95], v[148:151]
  buffer_load_dwordx4 v11, s[4:7], s26 offen offset:2048  lds
  v_mfma_f32_16x16x32_bf16 v[152:155], a[128:131], a[96:99], v[152:155]
  ds_read_b64_tr_b16 a[162:163], v6 offset:50176
  v_mfma_f32_16x16x32_bf16 v[156:159], a[132:135], a[80:83], v[156:159]
  ds_read_b64_tr_b16 a[164:165], v6 offset:49160
  v_mfma_f32_16x16x32_bf16 v[160:163], a[132:135], a[84:87], v[160:163]
  ds_read_b64_tr_b16 a[166:167], v6 offset:50184
  v_mfma_f32_16x16x32_bf16 v[164:167], a[132:135], a[88:91], v[164:167]
  ds_read_b64_tr_b16 a[168:169], v7 offset:49152
  v_mfma_f32_16x16x32_bf16 v[168:171], a[132:135], a[92:95], v[168:171]
  buffer_load_dwordx4 v12, s[4:7], s26 offen offset:3072  lds
  s_add_u32 m0, s29, 32768
  v_mfma_f32_16x16x32_bf16 v[172:175], a[132:135], a[96:99], v[172:175]
  ds_read_b64_tr_b16 a[170:171], v7 offset:50176
  v_mfma_f32_16x16x32_bf16 v[176:179], a[136:139], a[80:83], v[176:179]
  ds_read_b64_tr_b16 a[172:173], v7 offset:49160
  v_mfma_f32_16x16x32_bf16 v[180:183], a[136:139], a[84:87], v[180:183]
  ds_read_b64_tr_b16 a[174:175], v7 offset:50184
  v_mfma_f32_16x16x32_bf16 v[184:187], a[136:139], a[88:91], v[184:187]
  ds_read_b64_tr_b16 a[176:177], v8 offset:49152
  v_mfma_f32_16x16x32_bf16 v[188:191], a[136:139], a[92:95], v[188:191]
  s_add_u32 s26, s26, 262144
  buffer_load_dwordx4 v13, s[8:11], s27 offen offset:0  lds
  v_mfma_f32_16x16x32_bf16 v[192:195], a[136:139], a[96:99], v[192:195]
  ds_read_b64_tr_b16 a[178:179], v8 offset:50176
  v_mfma_f32_16x16x32_bf16 v[196:199], a[140:143], a[80:83], v[196:199]
  ds_read_b64_tr_b16 a[180:181], v8 offset:49160
  v_mfma_f32_16x16x32_bf16 v[200:203], a[140:143], a[84:87], v[200:203]
  ds_read_b64_tr_b16 a[182:183], v8 offset:50184
  v_mfma_f32_16x16x32_bf16 v[204:207], a[140:143], a[88:91], v[204:207]
  v_mfma_f32_16x16x32_bf16 v[208:211], a[140:143], a[92:95], v[208:211]
  buffer_load_dwordx4 v14, s[8:11], s27 offen offset:1024  lds
  v_mfma_f32_16x16x32_bf16 v[212:215], a[140:143], a[96:99], v[212:215]
  v_mfma_f32_16x16x32_bf16 v[216:219], a[144:147], a[80:83], v[216:219]
  v_mfma_f32_16x16x32_bf16 v[220:223], a[144:147], a[84:87], v[220:223]
  v_mfma_f32_16x16x32_bf16 v[224:227], a[144:147], a[88:91], v[224:227]
  v_mfma_f32_16x16x32_bf16 v[228:231], a[144:147], a[92:95], v[228:231]
  buffer_load_dwordx4 v15, s[8:11], s27 offen offset:2048  lds
  s_add_u32 s27, s27, 64
  v_mfma_f32_16x16x32_bf16 v[232:235], a[144:147], a[96:99], v[232:235]
  v_mfma_f32_16x16x32_bf16 v[236:239], a[148:151], a[80:83], v[236:239]
  s_cmp_eq_u32 s27, 1152
  v_mfma_f32_16x16x32_bf16 v[240:243], a[148:151], a[84:87], v[240:243]
  s_cselect_b32 s27, 0, s27
  v_mfma_f32_16x16x32_bf16 v[244:247], a[148:151], a[88:91], v[244:247]
  s_cselect_b32 s26, 0, s26
  v_mfma_f32_16x16x32_bf16 v[248:251], a[148:151], a[92:95], v[248:251]
  v_mfma_f32_16x16x32_bf16 v[252:255], a[148:151], a[96:99], v[252:255]
  s_waitcnt vmcnt(14) lgkmcnt(0)
  s_barrier
  v_mfma_f32_16x16x32_bf16 v[96:99], a[152:155], a[100:103], v[96:99]
  s_add_u32 m0, s28, 49152
  v_mfma_f32_16x16x32_bf16 v[100:103], a[152:155], a[104:107], v[100:103]
  ds_read_b128 a[80:83], v4 offset:0
  v_mfma_f32_16x16x32_bf16 v[104:107], a[152:155], a[108:111], v[104:107]
  ds_read_b128 a[84:87], v4 offset:1024
  v_mfma_f32_16x16x32_bf16 v[108:111], a[152:155], a[112:115], v[108:111]
  buffer_load_dwordx4 v9, s[4:7], s26 offen offset:0  lds
  v_mfma_f32_16x16x32_bf16 v[112:115], a[152:155], a[116:119], v[112:115]
  ds_read_b128 a[88:91], v4 offset:2048
  v_mfma_f32_16x16x32_bf16 v[116:119], a[156:159], a[100:103], v[116:119]
  ds_read_b128 a[92:95], v4 offset:3072
  v_mfma_f32_16x16x32_bf16 v[120:123], a[156:159], a[104:107], v[120:123]
  ds_read_b128 a[96:99], v4 offset:4096
  v_mfma_f32_16x16x32_bf16 v[124:127], a[156:159], a[108:111], v[124:127]
  ds_read_b64_tr_b16 a[120:121], v5 offset:0
  v_mfma_f32_16x16x32_bf16 v[128:131], a[156:159], a[112:115], v[128:131]
  buffer_load_dwordx4 v10, s[4:7], s26 offen offset:1024  lds
  v_mfma_f32_16x16x32_bf16 v[132:135], a[156:159], a[116:119], v[132:135]
  ds_read_b64_tr_b16 a[122:123], v5 offset:1024
  v_mfma_f32_16x16x32_bf16 v[136:139], a[160:163], a[100:103], v[136:139]
  ds_read_b64_tr_b16 a[124:125], v5 offset:8
  v_mfma_f32_16x16x32_bf16 v[140:143], a[160:163], a[104:107], v[140:143]
  ds_read_b64_tr_b16 a[126:127], v5 offset:1032
  v_mfma_f32_16x16x32_bf16 v[144:147], a[160:163], a[108:111], v[144:147]
  ds_read_b64_tr_b16 a[128:129], v6 offset:0
  v_mfma_f32_16x16x32_bf16 v[148:151], a[160:163], a[112:115], v[148:151]
  buffer_load_dwordx4 v11, s[4:7], s26 offen offset:2048  lds
  v_mfma_f32_16x16x32_bf16 v[152:155], a[160:163], a[116:119], v[152:155]
  ds_read_b64_tr_b16 a[130:131], v6 offset:1024
  v_mfma_f32_16x16x32_bf16 v[156:159], a[164:167], a[100:103], v[156:159]
  ds_read_b64_tr_b16 a[132:133], v6 offset:8
  v_mfma_f32_16x16x32_bf16 v[160:163], a[164:167], a[104:107], v[160:163]
  ds_read_b64_tr_b16 a[134:135], v6 offset:1032
  v_mfma_f32_16x16x32_bf16 v[164:167], a[164:167], a[108:111], v[164:167]
  ds_read_b64_tr_b16 a[136:137], v7 offset:0
  v_mfma_f32_16x16x32_bf16 v[168:171], a[164:167], a[112:115], v[168:171]
  buffer_load_dwordx4 v12, s[4:7], s26 offen offset:3072  lds
  s_add_u32 m0, s29, 131072
  v_mfma_f32_16x16x32_bf16 v[172:175], a[164:167], a[116:119], v[172:175]
  ds_read_b64_tr_b16 a[138:139], v7 offset:1024
  v_mfma_f32_16x16x32_bf16 v[176:179], a[168:171], a[100:103], v[176:179]
  ds_read_b64_tr_b16 a[140:141], v7 offset:8
  v_mfma_f32_16x16x32_bf16 v[180:183], a[168:171], a[104:107], v[180:183]
  ds_read_b64_tr_b16 a[142:143], v7 offset:1032
  v_mfma_f32_16x16x32_bf16 v[184:187], a[168:171], a[108:111], v[184:187]
  ds_read_b64_tr_b16 a[144:145], v8 offset:0
  v_mfma_f32_16x16x32_bf16 v[188:191], a[168:171], a[112:115], v[188:191]
  s_add_u32 s26, s26, 262144
  buffer_load_dwordx4 v13, s[8:11], s27 offen offset:0  lds
  v_mfma_f32_16x16x32_bf16 v[192:195], a[168:171], a[116:119], v[192:195]
  ds_read_b64_tr_b16 a[146:147], v8 offset:1024
  v_mfma_f32_16x16x32_bf16 v[196:199], a[172:175], a[100:103], v[196:199]
  ds_read_b64_tr_b16 a[148:149], v8 offset:8
  v_mfma_f32_16x16x32_bf16 v[200:203], a[172:175], a[104:107], v[200:203]
  ds_read_b64_tr_b16 a[150:151], v8 offset:1032
  v_mfma_f32_16x16x32_bf16 v[204:207], a[172:175], a[108:111], v[204:207]
  v_mfma_f32_16x16x32_bf16 v[208:211], a[172:175], a[112:115], v[208:211]
  buffer_load_dwordx4 v14, s[8:11], s27 offen offset:1024  lds
  v_mfma_f32_16x16x32_bf16 v[212:215], a[172:175], a[116:119], v[212:215]
  v_mfma_f32_16x16x32_bf16 v[216:219], a[176:179], a[100:103], v[216:219]
  v_mfma_f32_16x16x32_bf16 v[220:223], a[176:179], a[104:107], v[220:223]
  v_mfma_f32_16x16x32_bf16 v[224:227], a[176:179], a[108:111], v[224:227]
  v_mfma_f32_16x16x32_bf16 v[228:231], a[176:179], a[112:115], v[228:231]
  buffer_load_dwordx4 v15, s[8:11], s27 offen offset:2048  lds
  s_add_u32 s27, s27, 64
  v_mfma_f32_16x16x32_bf16 v[232:235], a[176:179], a[116:119], v[232:235]
  v_mfma_f32_16x16x32_bf16 v[236:239], a[180:183], a[100:103], v[236:239]
  s_cmp_eq_u32 s27, 1152
  v_mfma_f32_16x16x32_bf16 v[240:243], a[180:183], a[104:107], v[240:243]
  s_cselect_b32 s27, 0, s27
  v_mfma_f32_16x16x32_bf16 v[244:247], a[180:183], a[108:111], v[244:247]
  s_cselect_b32 s26, 0, s26
  v_mfma_f32_16x16x32_bf16 v[248:251], a[180:183], a[112:115], v[248:251]
  v_mfma_f32_16x16x32_bf16 v[252:255], a[180:183], a[116:119], v[252:255]
  s_waitcnt vmcnt(14) lgkmcnt(0)
  s_barrier
  v_mfma_f32_16x16x32_bf16 v[96:99], a[120:123], a[80:83], v[96:99]
  s_add_u32 m0, s39, 16384
  v_mfma_f32_16x16x32_bf16 v[100:103], a[120:123], a[84:87], v[100:103]
  ds_read_b128 a[100:103], v4 offset:16384
  v_mfma_f32_16x16x32_bf16 v[104:107], a[120:123], a[88:91], v[104:107]
  ds_read_b128 a[104:107], v4 offset:17408
  v_mfma_f32_16x16x32_bf16 v[108:111], a[120:123], a[92:95], v[108:111]
  buffer_load_dwordx4 v48, s[12:15], s36 offen offset:0 nt lds
  v_mfma_f32_16x16x32_bf16 v[112:115], a[120:123], a[96:99], v[112:115]
  ds_read_b128 a[108:111], v4 offset:18432
  v_mfma_f32_16x16x32_bf16 v[116:119], a[124:127], a[80:83], v[116:119]
  ds_read_b128 a[112:115], v4 offset:19456
  v_mfma_f32_16x16x32_bf16 v[120:123], a[124:127], a[84:87], v[120:123]
  ds_read_b128 a[116:119], v4 offset:20480
  v_mfma_f32_16x16x32_bf16 v[124:127], a[124:127], a[88:91], v[124:127]
  buffer_load_dwordx4 v49, s[12:15], s36 offen offset:1024 nt lds
  v_mfma_f32_16x16x32_bf16 v[128:131], a[124:127], a[92:95], v[128:131]
  ds_read_b64_tr_b16 a[152:153], v5 offset:16384
  v_mfma_f32_16x16x32_bf16 v[132:135], a[124:127], a[96:99], v[132:135]
  ds_read_b64_tr_b16 a[154:155], v5 offset:17408
  v_mfma_f32_16x16x32_bf16 v[136:139], a[128:131], a[80:83], v[136:139]
  ds_read_b64_tr_b16 a[156:157], v5 offset:16392
  v_mfma_f32_16x16x32_bf16 v[140:143], a[128:131], a[84:87], v[140:143]
  buffer_load_dwordx4 v50, s[12:15], s36 offen offset:2048 nt lds
  v_mfma_f32_16x16x32_bf16 v[144:147], a[128:131], a[88:91], v[144:147]
  ds_read_b64_tr_b16 a[158:159], v5 offset:17416
  v_mfma_f32_16x16x32_bf16 v[148:151], a[128:131], a[92:95], v[148:151]
  ds_read_b64_tr_b16 a[160:161], v6 offset:16384
  v_mfma_f32_16x16x32_bf16 v[152:155], a[128:131], a[96:99], v[152:155]
  ds_read_b64_tr_b16 a[162:163], v6 offset:17408
  v_mfma_f32_16x16x32_bf16 v[156:159], a[132:135], a[80:83], v[156:159]
  buffer_load_dwordx4 v51, s[12:15], s36 offen offset:3072 nt lds
  s_add_u32 s36, s36, 4096
  s_add_u32 m0, s39, 20480
  v_mfma_f32_16x16x32_bf16 v[160:163], a[132:135], a[84:87], v[160:163]
  ds_read_b64_tr_b16 a[164:165], v6 offset:16392
  v_mfma_f32_16x16x32_bf16 v[164:167], a[132:135], a[88:91], v[164:167]
  ds_read_b64_tr_b16 a[166:167], v6 offset:17416
  v_mfma_f32_16x16x32_bf16 v[168:171], a[132:135], a[92:95], v[168:171]
  ds_read_b64_tr_b16 a[168:169], v7 offset:16384
  v_mfma_f32_16x16x32_bf16 v[172:175], a[132:135], a[96:99], v[172:175]
  buffer_load_dwordx4 v48, s[12:15], s36 offen offset:0 nt lds
  v_mfma_f32_16x16x32_bf16 v[176:179], a[136:139], a[80:83], v[176:179]
  ds_read_b64_tr_b16 a[170:171], v7 offset:17408
  v_mfma_f32_16x16x32_bf16 v[180:183], a[136:139], a[84:87], v[180:183]
  ds_read_b64_tr_b16 a[172:173], v7 offset:16392
  v_mfma_f32_16x16x32_bf16 v[184:187], a[136:139], a[88:91], v[184:187]
  ds_read_b64_tr_b16 a[174:175], v7 offset:17416
  v_mfma_f32_16x16x32_bf16 v[188:191], a[136:139], a[92:95], v[188:191]
  buffer_load_dwordx4 v49, s[12:15], s36 offen offset:1024 nt lds
  v_mfma_f32_16x16x32_bf16 v[192:195], a[136:139], a[96:99], v[192:195]
  ds_read_b64_tr_b16 a[176:177], v8 offset:16384
  v_mfma_f32_16x16x32_bf16 v[196:199], a[140:143], a[80:83], v[196:199]
  ds_read_b64_tr_b16 a[178:179], v8 offset:17408
  v_mfma_f32_16x16x32_bf16 v[200:203], a[140:143], a[84:87], v[200:203]
  ds_read_b64_tr_b16 a[180:181], v8 offset:16392
  v_mfma_f32_16x16x32_bf16 v[204:207], a[140:143], a[88:91], v[204:207]
  buffer_load_dwordx4 v50, s[12:15], s36 offen offset:2048 nt lds
  v_mfma_f32_16x16x32_bf16 v[208:211], a[140:143], a[92:95], v[208:211]
  ds_read_b64_tr_b16 a[182:183], v8 offset:17416
  v_mfma_f32_16x16x32_bf16 v[212:215], a[140:143], a[96:99], v[212:215]
  v_mfma_f32_16x16x32_bf16 v[216:219], a[144:147], a[80:83], v[216:219]
  v_mfma_f32_16x16x32_bf16 v[220:223], a[144:147], a[84:87], v[220:223]
  buffer_load_dwordx4 v51, s[12:15], s36 offen offset:3072 nt lds
  s_add_u32 s36, s36, 4096
  v_mfma_f32_16x16x32_bf16 v[224:227], a[144:147], a[88:91], v[224:227]
  v_mfma_f32_16x16x32_bf16 v[228:231], a[144:147], a[92:95], v[228:231]
  v_mfma_f32_16x16x32_bf16 v[232:235], a[144:147], a[96:99], v[232:235]
  v_mfma_f32_16x16x32_bf16 v[236:239], a[148:151], a[80:83], v[236:239]
  v_mfma_f32_16x16x32_bf16 v[240:243], a[148:151], a[84:87], v[240:243]
  v_mfma_f32_16x16x32_bf16 v[244:247], a[148:151], a[88:91], v[244:247]
  v_mfma_f32_16x16x32_bf16 v[248:251], a[148:151], a[92:95], v[248:251]
  v_mfma_f32_16x16x32_bf16 v[252:255], a[148:151], a[96:99], v[252:255]
  s_waitcnt vmcnt(15) lgkmcnt(0)
  s_barrier
  v_mfma_f32_16x16x32_bf16 v[96:99], a[152:155], a[100:103], v[96:99]
  s_add_u32 m0, s39, 32768
  v_mfma_f32_16x16x32_bf16 v[100:103], a[152:155], a[104:107], v[100:103]
  ds_read_b128 a[80:83], v4 offset:32768
  v_mfma_f32_16x16x32_bf16 v[104:107], a[152:155], a[108:111], v[104:107]
  ds_read_b128 a[84:87], v4 offset:33792
  v_mfma_f32_16x16x32_bf16 v[108:111], a[152:155], a[112:115], v[108:111]
  buffer_load_dwordx4 v48, s[12:15], s36 offen offset:0 nt lds
  v_mfma_f32_16x16x32_bf16 v[112:115], a[152:155], a[116:119], v[112:115]
  ds_read_b128 a[88:91], v4 offset:34816
  v_mfma_f32_16x16x32_bf16 v[116:119], a[156:159], a[100:103], v[116:119]
  ds_read_b128 a[92:95], v4 offset:35840
  v_mfma_f32_16x16x32_bf16 v[120:123], a[156:159], a[104:107], v[120:123]
  ds_read_b128 a[96:99], v4 offset:36864
  v_mfma_f32_16x16x32_bf16 v[124:127], a[156:159], a[108:111], v[124:127]
  buffer_load_dwordx4 v49, s[12:15], s36 offen offset:1024 nt lds
  v_mfma_f32_16x16x32_bf16 v[128:131], a[156:159], a[112:115], v[128:131]
  ds_read_b64_tr_b16 a[120:121], v5 offset:32768
  v_mfma_f32_16x16x32_bf16 v[132:135], a[156:159], a[116:119], v[132:135]
  ds_read_b64_tr_b16 a[122:123], v5 offset:33792
  v_mfma_f32_16x16x32_bf16 v[136:139], a[160:163], a[100:103], v[136:139]
  ds_read_b64_tr_b16 a[124:125], v5 offset:32776
  v_mfma_f32_16x16x32_bf16 v[140:143], a[160:163], a[104:107], v[140:143]
  buffer_load_dwordx4 v50, s[12:15], s36 offen offset:2048 nt lds
  v_mfma_f32_16x16x32_bf16 v[144:147], a[160:163], a[108:111], v[144:147]
  ds_read_b64_tr_b16 a[126:127], v5 offset:33800
  v_mfma_f32_16x16x32_bf16 v[148:151], a[160:163], a[112:115], v[148:151]
  ds_read_b64_tr_b16 a[128:129], v6 offset:32768
  v_mfma_f32_16x16x32_bf16 v[152:155], a[160:163], a[116:119], v[152:155]
  ds_read_b64_tr_b16 a[130:131], v6 offset:33792
  v_mfma_f32_16x16x32_bf16 v[156:159], a[164:167], a[100:103], v[156:159]
  buffer_load_dwordx4 v51, s[12:15], s36 offen offset:3072 nt lds
  s_add_u32 s36, s36, 4096
  s_add_u32 m0, s39, 36864
  v_mfma_f32_16x16x32_bf16 v[160:163], a[164:167], a[104:107], v[160:163]
  ds_read_b64_tr_b16 a[132:133], v6 offset:32776
  v_mfma_f32_16x16x32_bf16 v[164:167], a[164:167], a[108:111], v[164:167]
  ds_read_b64_tr_b16 a[134:135], v6 offset:33800
  v_mfma_f32_16x16x32_bf16 v[168:171], a[164:167], a[112:115], v[168:171]
  ds_read_b64_tr_b16 a[136:137], v7 offset:32768
  v_mfma_f32_16x16x32_bf16 v[172:175], a[164:167], a[116:119], v[172:175]
  buffer_load_dwordx4 v48, s[12:15], s36 offen offset:0 nt lds
  v_mfma_f32_16x16x32_bf16 v[176:179], a[168:171], a[100:103], v[176:179]
  ds_read_b64_tr_b16 a[138:139], v7 offset:33792
  v_mfma_f32_16x16x32_bf16 v[180:183], a[168:171], a[104:107], v[180:183]
  ds_read_b64_tr_b16 a[140:141], v7 offset:32776
  v_mfma_f32_16x16x32_bf16 v[184:187], a[168:171], a[108:111], v[184:187]
  ds_read_b64_tr_b16 a[142:143], v7 offset:33800
  v_mfma_f32_16x16x32_bf16 v[188:191], a[168:171], a[112:115], v[188:191]
  buffer_load_dwordx4 v49, s[12:15], s36 offen offset:1024 nt lds
  v_mfma_f32_16x16x32_bf16 v[192:195], a[168:171], a[116:119], v[192:195]
  ds_read_b64_tr_b16 a[144:145], v8 offset:32768
  v_mfma_f32_16x16x32_bf16 v[196:199], a[172:175], a[100:103], v[196:199]
  ds_read_b64_tr_b16 a[146:147], v8 offset:33792
  v_mfma_f32_16x16x32_bf16 v[200:203], a[172:175], a[104:107], v[200:203]
  ds_read_b64_tr_b16 a[148:149], v8 offset:32776
  v_mfma_f32_16x16x32_bf16 v[204:207], a[172:175], a[108:111], v[204:207]
  buffer_load_dwordx4 v50, s[12:15], s36 offen offset:2048 nt lds
  v_mfma_f32_16x16x32_bf16 v[208:211], a[172:175], a[112:115], v[208:211]
  ds_read_b64_tr_b16 a[150:151], v8 offset:33800
  v_mfma_f32_16x16x32_bf16 v[212:215], a[172:175], a[116:119], v[212:215]
  v_mfma_f32_16x16x32_bf16 v[216:219], a[176:179], a[100:103], v[216:219]
  v_mfma_f32_16x16x32_bf16 v[220:223], a[176:179], a[104:107], v[220:223]
  buffer_load_dwordx4 v51, s[12:15], s36 offen offset:3072 nt lds
  s_add_u32 s36, s36, 4096
  v_mfma_f32_16x16x32_bf16 v[224:227], a[176:179], a[108:111], v[224:227]
  v_mfma_f32_16x16x32_bf16 v[228:231], a[176:179], a[112:115], v[228:231]
  v_mfma_f32_16x16x32_bf16 v[232:235], a[176:179], a[116:119], v[232:235]
  v_mfma_f32_16x16x32_bf16 v[236:239], a[180:183], a[100:103], v[236:239]
  v_mfma_f32_16x16x32_bf16 v[240:243], a[180:183], a[104:107], v[240:243]
  v_mfma_f32_16x16x32_bf16 v[244:247], a[180:183], a[108:111], v[244:247]
  v_mfma_f32_16x16x32_bf16 v[248:251], a[180:183], a[112:115], v[248:251]
  v_mfma_f32_16x16x32_bf16 v[252:255], a[180:183], a[116:119], v[252:255]
  s_waitcnt vmcnt(16) lgkmcnt(0)
  s_barrier
  v_mfma_f32_16x16x32_bf16 v[96:99], a[120:123], a[80:83], v[96:99]
  s_add_u32 m0, s39, 49152
  v_mfma_f32_16x16x32_bf16 v[100:103], a[120:123], a[84:87], v[100:103]
  ds_read_b128 a[100:103], v3 offset:0
  v_mfma_f32_16x16x32_bf16 v[104:107], a[120:123], a[88:91], v[104:107]
  ds_read_b128 a[104:107], v3 offset:1024
  v_mfma_f32_16x16x32_bf16 v[108:111], a[120:123], a[92:95], v[108:111]
  buffer_load_dwordx4 v48, s[12:15], s36 offen offset:0 nt lds
  v_mfma_f32_16x16x32_bf16 v[112:115], a[120:123], a[96:99], v[112:115]
  ds_read_b128 a[108:111], v3 offset:2048
  v_mfma_f32_16x16x32_bf16 v[116:119], a[124:127], a[80:83], v[116:119]
  ds_read_b128 a[112:115], v3 offset:3072
  v_mfma_f32_16x16x32_bf16 v[120:123], a[124:127], a[84:87], v[120:123]
  ds_read_b128 a[116:119], v3 offset:4096
  v_mfma_f32_16x16x32_bf16 v[124:127], a[124:127], a[88:91], v[124:127]
  buffer_load_dwordx4 v49, s[12:15], s36 offen offset:1024 nt lds
  v_mfma_f32_16x16x32_bf16 v[128:131], a[124:127], a[92:95], v[128:131]
  ds_read_b64_tr_b16 a[152:153], v5 offset:49152
  v_mfma_f32_16x16x32_bf16 v[132:135], a[124:127], a[96:99], v[132:135]
  ds_read_b64_tr_b16 a[154:155], v5 offset:50176
  v_mfma_f32_16x16x32_bf16 v[136:139], a[128:131], a[80:83], v[136:139]
  ds_read_b64_tr_b16 a[156:157], v5 offset:49160
  v_mfma_f32_16x16x32_bf16 v[140:143], a[128:131], a[84:87], v[140:143]
  buffer_load_dwordx4 v50, s[12:15], s36 offen offset:2048 nt lds
  v_mfma_f32_16x16x32_bf16 v[144:147], a[128:131], a[88:91], v[144:147]
  ds_read_b64_tr_b16 a[158:159], v5 offset:50184
  v_mfma_f32_16x16x32_bf16 v[148:151], a[128:131], a[92:95], v[148:151]
  ds_read_b64_tr_b16 a[160:161], v6 offset:49152
  v_mfma_f32_16x16x32_bf16 v[152:155], a[128:131], a[96:99], v[152:155]
  ds_read_b64_tr_b16 a[162:163], v6 offset:50176
  v_mfma_f32_16x16x32_bf16 v[156:159], a[132:135], a[80:83], v[156:159]
  buffer_load_dwordx4 v51, s[12:15], s36 offen offset:3072 nt lds
  s_add_u32 s36, s36, 4096
  s_add_u32 m0, s39, 53248
  v_mfma_f32_16x16x32_bf16 v[160:163], a[132:135], a[84:87], v[160:163]
  ds_read_b64_tr_b16 a[164:165], v6 offset:49160
  v_mfma_f32_16x16x32_bf16 v[164:167], a[132:135], a[88:91], v[164:167]
  ds_read_b64_tr_b16 a[166:167], v6 offset:50184
  v_mfma_f32_16x16x32_bf16 v[168:171], a[132:135], a[92:95], v[168:171]
  ds_read_b64_tr_b16 a[168:169], v7 offset:49152
  v_mfma_f32_16x16x32_bf16 v[172:175], a[132:135], a[96:99], v[172:175]
  buffer_load_dwordx4 v48, s[12:15], s36 offen offset:0 nt lds
  v_mfma_f32_16x16x32_bf16 v[176:179], a[136:139], a[80:83], v[176:179]
  ds_read_b64_tr_b16 a[170:171], v7 offset:50176
  v_mfma_f32_16x16x32_bf16 v[180:183], a[136:139], a[84:87], v[180:183]
  ds_read_b64_tr_b16 a[172:173], v7 offset:49160
  v_mfma_f32_16x16x32_bf16 v[184:187], a[136:139], a[88:91], v[184:187]
  ds_read_b64_tr_b16 a[174:175], v7 offset:50184
  v_mfma_f32_16x16x32_bf16 v[188:191], a[136:139], a[92:95], v[188:191]
  buffer_load_dwordx4 v49, s[12:15], s36 offen offset:1024 nt lds
  v_mfma_f32_16x16x32_bf16 v[192:195], a[136:139], a[96:99], v[192:195]
  ds_read_b64_tr_b16 a[176:177], v8 offset:49152
  v_mfma_f32_16x16x32_bf16 v[196:199], a[140:143], a[80:83], v[196:199]
  ds_read_b64_tr_b16 a[178:179], v8 offset:50176
  v_mfma_f32_16x16x32_bf16 v[200:203], a[140:143], a[84:87], v[200:203]
  ds_read_b64_tr_b16 a[180:181], v8 offset:49160
  v_mfma_f32_16x16x32_bf16 v[204:207], a[140:143], a[88:91], v[204:207]
  buffer_load_dwordx4 v50, s[12:15], s36 offen offset:2048 nt lds
  v_mfma_f32_16x16x32_bf16 v[208:211], a[140:143], a[92:95], v[208:211]
  ds_read_b64_tr_b16 a[182:183], v8 offset:50184
  v_mfma_f32_16x16x32_bf16 v[212:215], a[140:143], a[96:99], v[212:215]
  v_mfma_f32_16x16x32_bf16 v[216:219], a[144:147], a[80:83], v[216:219]
  v_mfma_f32_16x16x32_bf16 v[220:223], a[144:147], a[84:87], v[220:223]
  buffer_load_dwordx4 v51, s[12:15], s36 offen offset:3072 nt lds
  s_add_u32 s36, s36, 4096
  v_mfma_f32_16x16x32_bf16 v[224:227], a[144:147], a[88:91], v[224:227]
  v_mfma_f32_16x16x32_bf16 v[228:231], a[144:147], a[92:95], v[228:231]
  v_mfma_f32_16x16x32_bf16 v[232:235], a[144:147], a[96:99], v[232:235]
  v_mfma_f32_16x16x32_bf16 v[236:239], a[148:151], a[80:83], v[236:239]
  v_mfma_f32_16x16x32_bf16 v[240:243], a[148:151], a[84:87], v[240:243]
  v_mfma_f32_16x16x32_bf16 v[244:247], a[148:151], a[88:91], v[244:247]
  v_mfma_f32_16x16x32_bf16 v[248:251], a[148:151], a[92:95], v[248:251]
  v_mfma_f32_16x16x32_bf16 v[252:255], a[148:151], a[96:99], v[252:255]
  s_waitcnt lgkmcnt(0)
  s_barrier
  buffer_load_dword v19, v17, s[48:51], 0 offen
  buffer_load_dword v19, v18, s[48:51], 0 offen
  v_mfma_f32_16x16x32_bf16 v[96:99], a[152:155], a[100:103], v[96:99]
  v_mfma_f32_16x16x32_bf16 v[100:103], a[152:155], a[104:107], v[100:103]
  v_mfma_f32_16x16x32_bf16 v[104:107], a[152:155], a[108:111], v[104:107]
  v_mfma_f32_16x16x32_bf16 v[108:111], a[152:155], a[112:115], v[108:111]
  v_mfma_f32_16x16x32_bf16 v[112:115], a[152:155], a[116:119], v[112:115]
  v_mfma_f32_16x16x32_bf16 v[116:119], a[156:159], a[100:103], v[116:119]
  v_mfma_f32_16x16x32_bf16 v[120:123], a[156:159], a[104:107], v[120:123]
  v_mfma_f32_16x16x32_bf16 v[124:127], a[156:159], a[108:111], v[124:127]
  v_mfma_f32_16x16x32_bf16 v[128:131], a[156:159], a[112:115], v[128:131]
  v_mfma_f32_16x16x32_bf16 v[132:135], a[156:159], a[116:119], v[132:135]
  v_mfma_f32_16x16x32_bf16 v[136:139], a[160:163], a[100:103], v[136:139]
  v_mfma_f32_16x16x32_bf16 v[140:143], a[160:163], a[104:107], v[140:143]
  v_mfma_f32_16x16x32_bf16 v[144:147], a[160:163], a[108:111], v[144:147]
  v_mfma_f32_16x16x32_bf16 v[148:151], a[160:163], a[112:115], v[148:151]
  v_mfma_f32_16x16x32_bf16 v[152:155], a[160:163], a[116:119], v[152:155]
  v_pk_mul_f32 v[96:97], v[96:97], s[70:71]
  v_pk_mul_f32 v[98:99], v[98:99], s[70:71]
  v_mfma_f32_16x16x32_bf16 v[156:159], a[164:167], a[100:103], v[156:159]
  v_pk_mul_f32 v[116:117], v[116:117], s[70:71]
  v_pk_mul_f32 v[118:119], v[118:119], s[70:71]
  v_mfma_f32_16x16x32_bf16 v[160:163], a[164:167], a[104:107], v[160:163]
  v_cvt_pk_bf16_f32 v20, v96, v97
  v_cvt_pk_bf16_f32 v21, v98, v99
  v_mfma_f32_16x16x32_bf16 v[164:167], a[164:167], a[108:111], v[164:167]
  v_cvt_pk_bf16_f32 v22, v116, v117
  v_cvt_pk_bf16_f32 v23, v118, v119
  v_mfma_f32_16x16x32_bf16 v[168:171], a[164:167], a[112:115], v[168:171]
  v_accvgpr_write_b32 a0, v20
  v_accvgpr_write_b32 a1, v21
  v_mfma_f32_16x16x32_bf16 v[172:175], a[164:167], a[116:119], v[172:175]
  v_accvgpr_write_b32 a2, v22
  v_accvgpr_write_b32 a3, v23
  v_mfma_f32_16x16x32_bf16 v[176:179], a[168:171], a[100:103], v[176:179]
  v_pk_mul_f32 v[100:101], v[100:101], s[70:71]
  v_pk_mul_f32 v[102:103], v[102:103], s[70:71]
  v_mfma_f32_16x16x32_bf16 v[180:183], a[168:171], a[104:107], v[180:183]
  v_pk_mul_f32 v[120:121], v[120:121], s[70:71]
  v_pk_mul_f32 v[122:123], v[122:123], s[70:71]
  v_mfma_f32_16x16x32_bf16 v[184:187], a[168:171], a[108:111], v[184:187]
  v_cvt_pk_bf16_f32 v24, v100, v101
  v_cvt_pk_bf16_f32 v25, v102, v103
  v_mfma_f32_16x16x32_bf16 v[188:191], a[168:171], a[112:115], v[188:191]
  v_cvt_pk_bf16_f32 v26, v120, v121
  v_cvt_pk_bf16_f32 v27, v122, v123
  v_mfma_f32_16x16x32_bf16 v[192:195], a[168:171], a[116:119], v[192:195]
  v_accvgpr_write_b32 a16, v24
  v_accvgpr_write_b32 a17, v25
  v_mfma_f32_16x16x32_bf16 v[196:199], a[172:175], a[100:103], v[196:199]
  v_accvgpr_write_b32 a18, v26
  v_accvgpr_write_b32 a19, v27
  v_mfma_f32_16x16x32_bf16 v[200:203], a[172:175], a[104:107], v[200:203]
  v_pk_mul_f32 v[104:105], v[104:105], s[70:71]
  v_pk_mul_f32 v[106:107], v[106:107], s[70:71]
  v_mfma_f32_16x16x32_bf16 v[204:207], a[172:175], a[108:111], v[204:207]
  v_pk_mul_f32 v[124:125], v[124:125], s[70:71]
  v_pk_mul_f32 v[126:127], v[126:127], s[70:71]
  v_mfma_f32_16x16x32_bf16 v[208:211], a[172:175], a[112:115], v[208:211]
  v_cvt_pk_bf16_f32 v28, v104, v105
  v_cvt_pk_bf16_f32 v29, v106, v107
  v_mfma_f32_16x16x32_bf16 v[212:215], a[172:175], a[116:119], v[212:215]
  v_cvt_pk_bf16_f32 v30, v124, v125
  v_cvt_pk_bf16_f32 v31, v126, v127
  v_mfma_f32_16x16x32_bf16 v[216:219], a[176:179], a[100:103], v[216:219]
  v_accvgpr_write_b32 a32, v28
  v_accvgpr_write_b32 a33, v29
  v_mfma_f32_16x16x32_bf16 v[220:223], a[176:179], a[104:107], v[220:223]
  v_accvgpr_write_b32 a34, v30
  v_accvgpr_write_b32 a35, v31
  v_mfma_f32_16x16x32_bf16 v[224:227], a[176:179], a[108:111], v[224:227]
  v_pk_mul_f32 v[108:109], v[108:109], s[70:71]
  v_pk_mul_f32 v[110:111], v[110:111], s[70:71]
  v_mfma_f32_16x16x32_bf16 v[228:231], a[176:179], a[112:115], v[228:231]
  v_pk_mul_f32 v[128:129], v[128:129], s[70:71]
  v_pk_mul_f32 v[130:131], v[130:131], s[70:71]
  v_mfma_f32_16x16x32_bf16 v[232:235], a[176:179], a[116:119], v[232:235]
  v_cvt_pk_bf16_f32 v32, v108, v109
  v_cvt_pk_bf16_f32 v33, v110, v111
  v_mfma_f32_16x16x32_bf16 v[236:239], a[180:183], a[100:103], v[236:239]
  v_cvt_pk_bf16_f32 v34, v128, v129
  v_cvt_pk_bf16_f32 v35, v130, v131
  v_mfma_f32_16x16x32_bf16 v[240:243], a[180:183], a[104:107], v[240:243]
  v_accvgpr_write_b32 a48, v32
  v_accvgpr_write_b32 a49, v33
  v_mfma_f32_16x16x32_bf16 v[244:247], a[180:183], a[108:111], v[244:247]
  v_accvgpr_write_b32 a50, v34
  v_accvgpr_write_b32 a51, v35
  v_mfma_f32_16x16x32_bf16 v[248:251], a[180:183], a[112:115], v[248:251]
  v_pk_mul_f32 v[112:113], v[112:113], s[70:71]
  v_pk_mul_f32 v[114:115], v[114:115], s[70:71]
  v_mfma_f32_16x16x32_bf16 v[252:255], a[180:183], a[116:119], v[252:255]
  v_pk_mul_f32 v[132:133], v[132:133], s[70:71]
  v_pk_mul_f32 v[134:135], v[134:135], s[70:71]
  s_nop 7
  v_cvt_pk_bf16_f32 v20, v112, v113
  v_cvt_pk_bf16_f32 v21, v114, v115
  v_cvt_pk_bf16_f32 v22, v132, v133
  v_cvt_pk_bf16_f32 v23, v134, v135
  v_accvgpr_write_b32 a64, v20
  v_accvgpr_write_b32 a65, v21
  v_accvgpr_write_b32 a66, v22
  v_accvgpr_write_b32 a67, v23
  v_pk_mul_f32 v[136:137], v[136:137], s[70:71]
  v_pk_mul_f32 v[138:139], v[138:139], s[70:71]
  v_pk_mul_f32 v[156:157], v[156:157], s[70:71]
  v_pk_mul_f32 v[158:159], v[158:159], s[70:71]
  v_cvt_pk_bf16_f32 v24, v136, v137
  v_cvt_pk_bf16_f32 v25, v138, v139
  v_cvt_pk_bf16_f32 v26, v156, v157
  v_cvt_pk_bf16_f32 v27, v158, v159
  v_accvgpr_write_b32 a4, v24
  v_accvgpr_write_b32 a5, v25
  v_accvgpr_write_b32 a6, v26
  v_accvgpr_write_b32 a7, v27
  v_pk_mul_f32 v[140:141], v[140:141], s[70:71]
  v_pk_mul_f32 v[142:143], v[142:143], s[70:71]
  v_pk_mul_f32 v[160:161], v[160:161], s[70:71]
  v_pk_mul_f32 v[162:163], v[162:163], s[70:71]
  v_cvt_pk_bf16_f32 v28, v140, v141
  v_cvt_pk_bf16_f32 v29, v142, v143
  v_cvt_pk_bf16_f32 v30, v160, v161
  v_cvt_pk_bf16_f32 v31, v162, v163
  v_accvgpr_write_b32 a20, v28
  v_accvgpr_write_b32 a21, v29
  v_accvgpr_write_b32 a22, v30
  v_accvgpr_write_b32 a23, v31
  v_pk_mul_f32 v[144:145], v[144:145], s[70:71]
  v_pk_mul_f32 v[146:147], v[146:147], s[70:71]
  v_pk_mul_f32 v[164:165], v[164:165], s[70:71]
  v_pk_mul_f32 v[166:167], v[166:167], s[70:71]
  v_cvt_pk_bf16_f32 v32, v144, v145
  v_cvt_pk_bf16_f32 v33, v146, v147
  v_cvt_pk_bf16_f32 v34, v164, v165
  v_cvt_pk_bf16_f32 v35, v166, v167
  v_accvgpr_write_b32 a36, v32
  v_accvgpr_write_b32 a37, v33
  v_accvgpr_write_b32 a38, v34
  v_accvgpr_write_b32 a39, v35
  v_pk_mul_f32 v[148:149], v[148:149], s[70:71]
  v_pk_mul_f32 v[150:151], v[150:151], s[70:71]
  v_pk_mul_f32 v[168:169], v[168:169], s[70:71]
  v_pk_mul_f32 v[170:171], v[170:171], s[70:71]
  v_cvt_pk_bf16_f32 v20, v148, v149
  v_cvt_pk_bf16_f32 v21, v150, v151
  v_cvt_pk_bf16_f32 v22, v168, v169
  v_cvt_pk_bf16_f32 v23, v170, v171
  v_accvgpr_write_b32 a52, v20
  v_accvgpr_write_b32 a53, v21
  v_accvgpr_write_b32 a54, v22
  v_accvgpr_write_b32 a55, v23
  v_pk_mul_f32 v[152:153], v[152:153], s[70:71]
  v_pk_mul_f32 v[154:155], v[154:155], s[70:71]
  v_pk_mul_f32 v[172:173], v[172:173], s[70:71]
  v_pk_mul_f32 v[174:175], v[174:175], s[70:71]
  v_cvt_pk_bf16_f32 v24, v152, v153
  v_cvt_pk_bf16_f32 v25, v154, v155
  v_cvt_pk_bf16_f32 v26, v172, v173
  v_cvt_pk_bf16_f32 v27, v174, v175
  v_accvgpr_write_b32 a68, v24
  v_accvgpr_write_b32 a69, v25
  v_accvgpr_write_b32 a70, v26
  v_accvgpr_write_b32 a71, v27
  v_pk_mul_f32 v[176:177], v[176:177], s[70:71]
  v_pk_mul_f32 v[178:179], v[178:179], s[70:71]
  v_pk_mul_f32 v[196:197], v[196:197], s[70:71]
  v_pk_mul_f32 v[198:199], v[198:199], s[70:71]
  v_cvt_pk_bf16_f32 v28, v176, v177
  v_cvt_pk_bf16_f32 v29, v178, v179
  v_cvt_pk_bf16_f32 v30, v196, v197
  v_cvt_pk_bf16_f32 v31, v198, v199
  v_accvgpr_write_b32 a8, v28
  v_accvgpr_write_b32 a9, v29
  v_accvgpr_write_b32 a10, v30
  v_accvgpr_write_b32 a11, v31
  v_pk_mul_f32 v[180:181], v[180:181], s[70:71]
  v_pk_mul_f32 v[182:183], v[182:183], s[70:71]
  v_pk_mul_f32 v[200:201], v[200:201], s[70:71]
  v_pk_mul_f32 v[202:203], v[202:203], s[70:71]
  v_cvt_pk_bf16_f32 v32, v180, v181
  v_cvt_pk_bf16_f32 v33, v182, v183
  v_cvt_pk_bf16_f32 v34, v200, v201
  v_cvt_pk_bf16_f32 v35, v202, v203
  v_accvgpr_write_b32 a24, v32
  v_accvgpr_write_b32 a25, v33
  v_accvgpr_write_b32 a26, v34
  v_accvgpr_write_b32 a27, v35
  v_pk_mul_f32 v[184:185], v[184:185], s[70:71]
  v_pk_mul_f32 v[186:187], v[186:187], s[70:71]
  v_pk_mul_f32 v[204:205], v[204:205], s[70:71]
  v_pk_mul_f32 v[206:207], v[206:207], s[70:71]
  v_cvt_pk_bf16_f32 v20, v184, v185
  v_cvt_pk_bf16_f32 v21, v186, v187
  v_cvt_pk_bf16_f32 v22, v204, v205
  v_cvt_pk_bf16_f32 v23, v206, v207
  v_accvgpr_write_b32 a40, v20
  v_accvgpr_write_b32 a41, v21
  v_accvgpr_write_b32 a42, v22
  v_accvgpr_write_b32 a43, v23
  v_pk_mul_f32 v[188:189], v[188:189], s[70:71]
  v_pk_mul_f32 v[190:191], v[190:191], s[70:71]
  v_pk_mul_f32 v[208:209], v[208:209], s[70:71]
  v_pk_mul_f32 v[210:211], v[210:211], s[70:71]
  v_cvt_pk_bf16_f32 v24, v188, v189
  v_cvt_pk_bf16_f32 v25, v190, v191
  v_cvt_pk_bf16_f32 v26, v208, v209
  v_cvt_pk_bf16_f32 v27, v210, v211
  v_accvgpr_write_b32 a56, v24
  v_accvgpr_write_b32 a57, v25
  v_accvgpr_write_b32 a58, v26
  v_accvgpr_write_b32 a59, v27
  v_pk_mul_f32 v[192:193], v[192:193], s[70:71]
  v_pk_mul_f32 v[194:195], v[194:195], s[70:71]
  v_pk_mul_f32 v[212:213], v[212:213], s[70:71]
  v_pk_mul_f32 v[214:215], v[214:215], s[70:71]
  v_cvt_pk_bf16_f32 v28, v192, v193
  v_cvt_pk_bf16_f32 v29, v194, v195
  v_cvt_pk_bf16_f32 v30, v212, v213
  v_cvt_pk_bf16_f32 v31, v214, v215
  v_accvgpr_write_b32 a72, v28
  v_accvgpr_write_b32 a73, v29
  v_accvgpr_write_b32 a74, v30
  v_accvgpr_write_b32 a75, v31
  v_pk_mul_f32 v[216:217], v[216:217], s[70:71]
  v_pk_mul_f32 v[218:219], v[218:219], s[70:71]
  v_pk_mul_f32 v[236:237], v[236:237], s[70:71]
  v_pk_mul_f32 v[238:239], v[238:239], s[70:71]
  v_cvt_pk_bf16_f32 v32, v216, v217
  v_cvt_pk_bf16_f32 v33, v218, v219
  v_cvt_pk_bf16_f32 v34, v236, v237
  v_cvt_pk_bf16_f32 v35, v238, v239
  v_accvgpr_write_b32 a12, v32
  v_accvgpr_write_b32 a13, v33
  v_accvgpr_write_b32 a14, v34
  v_accvgpr_write_b32 a15, v35
  v_pk_mul_f32 v[220:221], v[220:221], s[70:71]
  v_pk_mul_f32 v[222:223], v[222:223], s[70:71]
  v_pk_mul_f32 v[240:241], v[240:241], s[70:71]
  v_pk_mul_f32 v[242:243], v[242:243], s[70:71]
  v_cvt_pk_bf16_f32 v20, v220, v221
  v_cvt_pk_bf16_f32 v21, v222, v223
  v_cvt_pk_bf16_f32 v22, v240, v241
  v_cvt_pk_bf16_f32 v23, v242, v243
  v_accvgpr_write_b32 a28, v20
  v_accvgpr_write_b32 a29, v21
  v_accvgpr_write_b32 a30, v22
  v_accvgpr_write_b32 a31, v23
  v_pk_mul_f32 v[224:225], v[224:225], s[70:71]
  v_pk_mul_f32 v[226:227], v[226:227], s[70:71]
  v_pk_mul_f32 v[244:245], v[244:245], s[70:71]
  v_pk_mul_f32 v[246:247], v[246:247], s[70:71]
  v_cvt_pk_bf16_f32 v24, v224, v225
  v_cvt_pk_bf16_f32 v25, v226, v227
  v_cvt_pk_bf16_f32 v26, v244, v245
  v_cvt_pk_bf16_f32 v27, v246, v247
  v_accvgpr_write_b32 a44, v24
  v_accvgpr_write_b32 a45, v25
  v_accvgpr_write_b32 a46, v26
  v_accvgpr_write_b32 a47, v27
  v_pk_mul_f32 v[228:229], v[228:229], s[70:71]
  v_pk_mul_f32 v[230:231], v[230:231], s[70:71]
  v_pk_mul_f32 v[248:249], v[248:249], s[70:71]
  v_pk_mul_f32 v[250:251], v[250:251], s[70:71]
  v_cvt_pk_bf16_f32 v28, v228, v229
  v_cvt_pk_bf16_f32 v29, v230, v231
  v_cvt_pk_bf16_f32 v30, v248, v249
  v_cvt_pk_bf16_f32 v31, v250, v251
  v_accvgpr_write_b32 a60, v28
  v_accvgpr_write_b32 a61, v29
  v_accvgpr_write_b32 a62, v30
  v_accvgpr_write_b32 a63, v31
  v_pk_mul_f32 v[232:233], v[232:233], s[70:71]
  v_pk_mul_f32 v[234:235], v[234:235], s[70:71]
  v_pk_mul_f32 v[252:253], v[252:253], s[70:71]
  v_pk_mul_f32 v[254:255], v[254:255], s[70:71]
  v_cvt_pk_bf16_f32 v32, v232, v233
  v_cvt_pk_bf16_f32 v33, v234, v235
  v_cvt_pk_bf16_f32 v34, v252, v253
  v_cvt_pk_bf16_f32 v35, v254, v255
  v_accvgpr_write_b32 a76, v32
  v_accvgpr_write_b32 a77, v33
  v_accvgpr_write_b32 a78, v34
  v_accvgpr_write_b32 a79, v35
  s_cmp_lg_u32 s20, 0
  s_cbranch_scc1 PI_done
  v_cmp_eq_u32 vcc, 0, v1
  s_and_saveexec_b64 s[48:49], vcc
  s_cmp_lg_u32 s30, 0
  s_cbranch_scc1 PI_g
  s_lshl_b32 s45, s32, 2
  v_mov_b32 v20, s45
  v_mov_b32 v21, 1
  buffer_atomic_add v21, v20, s[60:63], 0 offen sc1
PI_g:
  s_cmp_lg_u32 s31, 0
  s_cbranch_scc1 PI_r
  s_lshl_b32 s45, s33, 2
  v_mov_b32 v22, s45
  v_mov_b32 v23, 16
  buffer_atomic_add v23, v22, s[60:63], 0 offen sc1
PI_r:
  s_mov_b64 exec, s[48:49]
PI_done:
  s_lshr_b32 s26, s2, 6
  s_bfe_u32 s27, s2, 0x20001
  s_lshl_b32 s44, s25, 3
  s_add_u32 s44, s44, s23
  s_lshl_b32 s44, s44, 2
  s_add_u32 s55, s44, s26
  s_add_u32 s44, s44, s27
  s_lshl_b32 s45, s20, 11
  v_add_u32 v2, s45, v16
  s_add_u32 s42, s45, 118784
  s_add_u32 s43, s45, 81920
  s_mov_b32 s47, 0x0e38e38f
  s_lshl_b32 s45, s20, 7
  v_add_u32 v20, s45, v1
  v_mul_hi_u32 v21, v20, s47
  v_mul_u32_u24 v22, 18, v21
  v_sub_u32 v22, v20, v22
  v_lshlrev_b32 v22, 4, v22
  v_mul_u32_u24 v21, 1152, v21
  v_add_u32 v21, v21, v22
  v_subrev_u32 v3, 0, v21
  s_add_u32 s45, s45, 64
  v_add_u32 v20, s45, v1
  v_mul_hi_u32 v21, v20, s47
  v_mul_u32_u24 v22, 18, v21
  v_sub_u32 v22, v20, v22
  v_lshlrev_b32 v22, 4, v22
  v_mul_u32_u24 v21, 1152, v21
  v_add_u32 v21, v21, v22
  v_subrev_u32 v4, 1024, v21
  v_add_u32 v20, 512, v1
  v_mul_hi_u32 v21, v20, s47
  v_mul_u32_u24 v22, 18, v21
  v_sub_u32 v22, v20, v22
  v_lshlrev_b32 v22, 4, v22
  v_mul_u32_u24 v21, 1152, v21
  v_add_u32 v21, v21, v22
  v_subrev_u32 v6, 0, v21
  s_cmp_lt_u32 s20, 2
  s_cbranch_scc0 O2_zW
  s_add_u32 s45, s20, 8
  s_lshl_b32 s45, s45, 10
  v_add_u32 v5, s45, v16
  s_add_u32 s50, s45, 118784
  s_add_u32 s51, s50, 10240
  s_add_u32 s52, s50, 20480
  s_add_u32 s53, s50, 30720
  s_mov_b32 s41, 10240
  s_branch O2_zD
O2_zW:
  v_mov_b32 v5, v6
  s_mov_b32 s50, 90112
  s_mov_b32 s51, 99328
  s_mov_b32 s52, 108544
  s_mov_b32 s53, 117760
  s_mov_b32 s41, 36864
O2_zD:
  s_mul_i32 s45, s44, 327680
  s_add_u32 s4, s64, s45
  s_addc_u32 s5, s65, 0
  s_mov_b32 s6, 327680
  s_mov_b32 s7, 0x20000
  s_mul_i32 s45, s27, 1179648
  s_add_u32 s28, s68, s45
  s_addc_u32 s29, s69, 0
  s_mov_b32 s30, 1179648
  s_mov_b32 s31, 0x20000
  s_mul_i32 s46, s26, 288
  s_add_u32 s8, s28, s46
  s_addc_u32 s9, s29, 0
  s_sub_u32 s10, 1179648, s46
  s_mov_b32 s11, 0x20000
  s_lshl_b32 s32, s26, 3
  s_mul_i32 s45, s21, 5120
  v_add_u32 v7, s45, v16
  v_add_u32 v8, 40960, v7
  v_add_u32 v9, 118784, v7
  s_mul_i32 s46, s22, 40960
  v_add_u32 v11, s46, v7
  v_lshrrev_b32 v20, 4, v1
  v_bfe_u32 v21, v1, 2, 2
  v_lshl_add_u32 v21, v20, 2, v21
  v_mul_u32_u24 v21, 288, v21
  v_and_b32 v22, 3, v1
  v_lshl_add_u32 v21, v22, 3, v21
  s_mul_i32 s45, s22, 128
  s_add_u32 s45, s45, 81920
  v_add_u32 v10, s45, v21
  s_lshr_b32 s45, s2, 3
  s_lshl_b32 s45, s45, 2
  s_add_u32 s45, s45, s20
  s_mul_i32 s45, s45, 72
  v_add_u32 v12, s45, v1
  v_lshlrev_b32 v12, 7, v12
  v_add_u32 v13, 8192, v12
  v_cmp_gt_u32 vcc, 8, v1
  v_mov_b32 v20, 0x80000000
  s_nop 1
  v_cndmask_b32 v13, v20, v13, vcc
  s_lshl_b32 s45, s44, 2
  v_mov_b32 v17, s45
  s_lshl_b32 s45, s55, 2
  v_mov_b32 v18, s45
  s_mov_b32 s37, 0
K1_ATTPRO:
  v_mfma_f32_32x32x16_bf16 v[96:111], a[232:235], a[232:235], 0
  v_mfma_f32_32x32x16_bf16 v[112:127], a[232:235], a[232:235], 0
  v_mfma_f32_32x32x16_bf16 v[128:143], a[232:235], a[232:235], 0
  v_mfma_f32_32x32x16_bf16 v[144:159], a[232:235], a[232:235], 0
  v_mfma_f32_32x32x16_bf16 v[160:175], a[232:235], a[232:235], 0
  v_mfma_f32_32x32x16_bf16 v[176:191], a[232:235], a[232:235], 0
  v_mfma_f32_32x32x16_bf16 v[192:207], a[232:235], a[232:235], 0
  v_mfma_f32_32x32x16_bf16 v[208:223], a[232:235], a[232:235], 0
  v_mfma_f32_32x32x16_bf16 v[224:239], a[232:235], a[232:235], 0
  v_mfma_f32_32x32x16_bf16 v[240:255], a[232:235], a[232:235], 0
  v_mfma_f32_32x32x16_bf16 a[176:191], a[232:235], a[232:235], 0
  v_mfma_f32_32x32x16_bf16 a[192:207], a[232:235], a[232:235], 0
  v_mfma_f32_32x32x16_bf16 a[208:223], a[232:235], a[232:235], 0
  v_mfma_f32_16x16x32_bf16 a[224:227], a[232:235], a[232:235], 0
  v_mov_b32 v76, 0
  v_mov_b32 v77, 0
  v_mov_b32 v78, 0
  v_mov_b32 v79, 0
  s_waitcnt vmcnt(16)
  s_barrier
  ds_read_b128 a[80:83], v36 offset:0
  ds_read_b128 a[96:99], v36 offset:4096
  ds_read_b128 a[84:87], v37 offset:0
  ds_read_b128 a[100:103], v37 offset:4096
  ds_read_b128 a[88:91], v38 offset:0
  ds_read_b128 a[104:107], v38 offset:4096
  ds_read_b128 a[92:95], v39 offset:0
  ds_read_b128 a[108:111], v39 offset:4096
  ds_read_b64_tr_b16 a[144:145], v40 offset:0
  ds_read_b64_tr_b16 a[146:147], v40 offset:4096
  ds_read_b64_tr_b16 a[148:149], v41 offset:0
  ds_read_b64_tr_b16 a[150:151], v41 offset:4096
  ds_read_b64_tr_b16 a[152:153], v42 offset:0
  ds_read_b64_tr_b16 a[154:155], v42 offset:4096
  ds_read_b64_tr_b16 a[156:157], v43 offset:0
  ds_read_b64_tr_b16 a[158:159], v43 offset:4096
  ds_read_b64_tr_b16 a[160:161], v44 offset:0
  ds_read_b64_tr_b16 a[162:163], v44 offset:4096
  ds_read_b64_tr_b16 a[164:165], v45 offset:0
  ds_read_b64_tr_b16 a[166:167], v45 offset:4096
  ds_read_b64_tr_b16 a[168:169], v46 offset:0
  ds_read_b64_tr_b16 a[170:171], v46 offset:4096
  ds_read_b64_tr_b16 a[172:173], v47 offset:0
  ds_read_b64_tr_b16 a[174:175], v47 offset:4096
  s_waitcnt lgkmcnt(0)
  s_barrier
  v_mfma_f32_16x16x32_bf16 v[80:83], a[80:83], a[0:3], v[52:55]
  v_mfma_f32_16x16x32_bf16 v[84:87], a[96:99], a[0:3], v[52:55]
  v_mfma_f32_16x16x32_bf16 v[80:83], a[84:87], a[4:7], v[80:83]
  v_mfma_f32_16x16x32_bf16 v[84:87], a[100:103], a[4:7], v[84:87]
  v_mfma_f32_16x16x32_bf16 v[80:83], a[88:91], a[8:11], v[80:83]
  v_mfma_f32_16x16x32_bf16 v[84:87], a[104:107], a[8:11], v[84:87]
  v_mfma_f32_16x16x32_bf16 v[80:83], a[92:95], a[12:15], v[80:83]
  v_mfma_f32_16x16x32_bf16 v[84:87], a[108:111], a[12:15], v[84:87]
  s_mov_b32 s40, 0
  s_nop 7
.p2align 4
ATT_loop:
  s_cmp_lg_u32 s40, 7
  s_cbranch_scc1 O2_noci
  buffer_load_dword v15, v17, s[60:63], 0 offen sc1
  buffer_load_dword v19, v18, s[60:63], 0 offen sc1
O2_noci:
  v_mfma_f32_16x16x32_bf16 v[88:91], a[80:83], a[16:19], v[56:59]
  v_exp_f32 v80, v80
  v_mfma_f32_16x16x32_bf16 v[92:95], a[96:99], a[16:19], v[56:59]
  s_add_u32 m0, s39, 0
  ds_read_b128 a[112:115], v36 offset:16384
  v_mfma_f32_16x16x32_bf16 v[88:91], a[84:87], a[20:23], v[88:91]
  v_exp_f32 v81, v81
  v_mfma_f32_16x16x32_bf16 v[92:95], a[100:103], a[20:23], v[92:95]
  v_cvt_pk_bf16_f32 v72, v80, v81
  buffer_load_dwordx4 v48, s[12:15], s36 offen offset:0 nt lds
  v_mfma_f32_16x16x32_bf16 v[88:91], a[88:91], a[24:27], v[88:91]
  v_exp_f32 v82, v82
  v_mfma_f32_16x16x32_bf16 v[92:95], a[104:107], a[24:27], v[92:95]
  ds_read_b128 a[128:131], v36 offset:20480
  ds_read_b128 a[116:119], v37 offset:16384
  v_mfma_f32_16x16x32_bf16 v[88:91], a[92:95], a[28:31], v[88:91]
  v_exp_f32 v83, v83
  v_mfma_f32_16x16x32_bf16 v[92:95], a[108:111], a[28:31], v[92:95]
  v_cvt_pk_bf16_f32 v73, v82, v83
  buffer_load_dwordx4 v49, s[12:15], s36 offen offset:1024 nt lds
  v_mfma_f32_16x16x32_bf16 a[224:227], a[228:231], v[76:79], a[224:227]
  v_exp_f32 v84, v84
  v_mfma_f32_16x16x32_bf16 v[112:115], a[176:179], v[76:79], v[112:115]
  ds_read_b128 a[132:135], v37 offset:20480
  ds_read_b128 a[120:123], v38 offset:16384
  v_mfma_f32_16x16x32_bf16 v[132:135], a[180:183], v[76:79], v[132:135]
  v_exp_f32 v85, v85
  v_mfma_f32_16x16x32_bf16 v[152:155], a[184:187], v[76:79], v[152:155]
  v_cvt_pk_bf16_f32 v74, v84, v85
  buffer_load_dwordx4 v50, s[12:15], s36 offen offset:2048 nt lds
  v_mfma_f32_16x16x32_bf16 v[172:175], a[188:191], v[76:79], v[172:175]
  v_exp_f32 v86, v86
  v_mfma_f32_16x16x32_bf16 v[192:195], a[192:195], v[76:79], v[192:195]
  ds_read_b128 a[136:139], v38 offset:20480
  ds_read_b128 a[124:127], v39 offset:16384
  v_mfma_f32_16x16x32_bf16 v[212:215], a[196:199], v[76:79], v[212:215]
  v_exp_f32 v87, v87
  v_mfma_f32_16x16x32_bf16 v[232:235], a[200:203], v[76:79], v[232:235]
  v_cvt_pk_bf16_f32 v75, v86, v87
  buffer_load_dwordx4 v51, s[12:15], s36 offen offset:3072 nt lds
  v_mfma_f32_16x16x32_bf16 v[252:255], a[204:207], v[76:79], v[252:255]
  s_add_u32 s36, s36, 4096
  ds_read_b128 a[140:143], v39 offset:20480
  v_mfma_f32_16x16x32_bf16 v[80:83], a[80:83], a[32:35], v[60:63]
  v_exp_f32 v88, v88
  v_mfma_f32_16x16x32_bf16 v[84:87], a[96:99], a[32:35], v[60:63]
  s_add_u32 m0, s39, 4096
  ds_read_b64_tr_b16 a[176:177], v40 offset:16384
  v_mfma_f32_16x16x32_bf16 v[80:83], a[84:87], a[36:39], v[80:83]
  v_exp_f32 v89, v89
  v_mfma_f32_16x16x32_bf16 v[84:87], a[100:103], a[36:39], v[84:87]
  v_cvt_pk_bf16_f32 v76, v88, v89
  buffer_load_dwordx4 v48, s[12:15], s36 offen offset:0 nt lds
  v_mfma_f32_16x16x32_bf16 v[80:83], a[88:91], a[40:43], v[80:83]
  v_exp_f32 v90, v90
  v_mfma_f32_16x16x32_bf16 v[84:87], a[104:107], a[40:43], v[84:87]
  ds_read_b64_tr_b16 a[178:179], v40 offset:20480
  ds_read_b64_tr_b16 a[180:181], v41 offset:16384
  v_mfma_f32_16x16x32_bf16 v[80:83], a[92:95], a[44:47], v[80:83]
  v_exp_f32 v91, v91
  v_mfma_f32_16x16x32_bf16 v[84:87], a[108:111], a[44:47], v[84:87]
  v_cvt_pk_bf16_f32 v77, v90, v91
  buffer_load_dwordx4 v49, s[12:15], s36 offen offset:1024 nt lds
  v_mfma_f32_16x16x32_bf16 a[208:211], a[228:231], v[72:75], a[208:211]
  v_exp_f32 v92, v92
  v_mfma_f32_16x16x32_bf16 v[96:99], a[144:147], v[72:75], v[96:99]
  ds_read_b64_tr_b16 a[182:183], v41 offset:20480
  ds_read_b64_tr_b16 a[184:185], v42 offset:16384
  v_mfma_f32_16x16x32_bf16 v[116:119], a[148:151], v[72:75], v[116:119]
  v_exp_f32 v93, v93
  v_mfma_f32_16x16x32_bf16 v[136:139], a[152:155], v[72:75], v[136:139]
  v_cvt_pk_bf16_f32 v78, v92, v93
  buffer_load_dwordx4 v50, s[12:15], s36 offen offset:2048 nt lds
  v_mfma_f32_16x16x32_bf16 v[156:159], a[156:159], v[72:75], v[156:159]
  v_exp_f32 v94, v94
  v_mfma_f32_16x16x32_bf16 v[176:179], a[160:163], v[72:75], v[176:179]
  ds_read_b64_tr_b16 a[186:187], v42 offset:20480
  v_mfma_f32_16x16x32_bf16 v[196:199], a[164:167], v[72:75], v[196:199]
  v_exp_f32 v95, v95
  v_mfma_f32_16x16x32_bf16 v[216:219], a[168:171], v[72:75], v[216:219]
  v_cvt_pk_bf16_f32 v79, v94, v95
  v_mfma_f32_16x16x32_bf16 v[236:239], a[172:175], v[72:75], v[236:239]
  v_mfma_f32_16x16x32_bf16 v[88:91], a[80:83], a[48:51], v[64:67]
  v_exp_f32 v80, v80
  v_mfma_f32_16x16x32_bf16 v[92:95], a[96:99], a[48:51], v[64:67]
  buffer_load_dwordx4 v51, s[12:15], s36 offen offset:3072 nt lds
  ds_read_b64_tr_b16 a[188:189], v43 offset:16384
  v_mfma_f32_16x16x32_bf16 v[88:91], a[84:87], a[52:55], v[88:91]
  v_exp_f32 v81, v81
  v_mfma_f32_16x16x32_bf16 v[92:95], a[100:103], a[52:55], v[92:95]
  v_cvt_pk_bf16_f32 v72, v80, v81
  s_add_u32 s36, s36, 4096
  v_mfma_f32_16x16x32_bf16 v[88:91], a[88:91], a[56:59], v[88:91]
  v_exp_f32 v82, v82
  v_mfma_f32_16x16x32_bf16 v[92:95], a[104:107], a[56:59], v[92:95]
  ds_read_b64_tr_b16 a[190:191], v43 offset:20480
  ds_read_b64_tr_b16 a[192:193], v44 offset:16384
  v_mfma_f32_16x16x32_bf16 v[88:91], a[92:95], a[60:63], v[88:91]
  v_exp_f32 v83, v83
  v_mfma_f32_16x16x32_bf16 v[92:95], a[108:111], a[60:63], v[92:95]
  v_cvt_pk_bf16_f32 v73, v82, v83
  ds_read_b64_tr_b16 a[194:195], v44 offset:20480
  v_mfma_f32_16x16x32_bf16 a[212:215], a[228:231], v[76:79], a[212:215]
  v_exp_f32 v84, v84
  v_mfma_f32_16x16x32_bf16 v[100:103], a[144:147], v[76:79], v[100:103]
  ds_read_b64_tr_b16 a[196:197], v45 offset:16384
  v_mfma_f32_16x16x32_bf16 v[120:123], a[148:151], v[76:79], v[120:123]
  v_exp_f32 v85, v85
  v_mfma_f32_16x16x32_bf16 v[140:143], a[152:155], v[76:79], v[140:143]
  v_cvt_pk_bf16_f32 v74, v84, v85
  v_mfma_f32_16x16x32_bf16 v[160:163], a[156:159], v[76:79], v[160:163]
  v_exp_f32 v86, v86
  v_mfma_f32_16x16x32_bf16 v[180:183], a[160:163], v[76:79], v[180:183]
  v_mfma_f32_16x16x32_bf16 v[200:203], a[164:167], v[76:79], v[200:203]
  v_exp_f32 v87, v87
  v_mfma_f32_16x16x32_bf16 v[220:223], a[168:171], v[76:79], v[220:223]
  v_cvt_pk_bf16_f32 v75, v86, v87
  v_mfma_f32_16x16x32_bf16 v[240:243], a[172:175], v[76:79], v[240:243]
  v_mfma_f32_16x16x32_bf16 v[80:83], a[80:83], a[64:67], v[68:71]
  v_exp_f32 v88, v88
  v_mfma_f32_16x16x32_bf16 v[84:87], a[96:99], a[64:67], v[68:71]
  ds_read_b64_tr_b16 a[198:199], v45 offset:20480
  ds_read_b64_tr_b16 a[200:201], v46 offset:16384
  v_mfma_f32_16x16x32_bf16 v[80:83], a[84:87], a[68:71], v[80:83]
  v_exp_f32 v89, v89
  v_mfma_f32_16x16x32_bf16 v[84:87], a[100:103], a[68:71], v[84:87]
  v_cvt_pk_bf16_f32 v76, v88, v89
  ds_read_b64_tr_b16 a[202:203], v46 offset:20480
  v_mfma_f32_16x16x32_bf16 v[80:83], a[88:91], a[72:75], v[80:83]
  v_exp_f32 v90, v90
  v_mfma_f32_16x16x32_bf16 v[84:87], a[104:107], a[72:75], v[84:87]
  ds_read_b64_tr_b16 a[204:205], v47 offset:16384
  ds_read_b64_tr_b16 a[206:207], v47 offset:20480
  v_mfma_f32_16x16x32_bf16 v[80:83], a[92:95], a[76:79], v[80:83]
  v_exp_f32 v91, v91
  v_mfma_f32_16x16x32_bf16 v[84:87], a[108:111], a[76:79], v[84:87]
  v_cvt_pk_bf16_f32 v77, v90, v91
  v_mfma_f32_16x16x32_bf16 a[216:219], a[228:231], v[72:75], a[216:219]
  v_exp_f32 v92, v92
  v_mfma_f32_16x16x32_bf16 v[104:107], a[144:147], v[72:75], v[104:107]
  v_mfma_f32_16x16x32_bf16 v[124:127], a[148:151], v[72:75], v[124:127]
  v_exp_f32 v93, v93
  v_mfma_f32_16x16x32_bf16 v[144:147], a[152:155], v[72:75], v[144:147]
  v_cvt_pk_bf16_f32 v78, v92, v93
  v_mfma_f32_16x16x32_bf16 v[164:167], a[156:159], v[72:75], v[164:167]
  v_exp_f32 v94, v94
  v_mfma_f32_16x16x32_bf16 v[184:187], a[160:163], v[72:75], v[184:187]
  v_mfma_f32_16x16x32_bf16 v[204:207], a[164:167], v[72:75], v[204:207]
  v_exp_f32 v95, v95
  v_mfma_f32_16x16x32_bf16 v[224:227], a[168:171], v[72:75], v[224:227]
  v_cvt_pk_bf16_f32 v79, v94, v95
  v_mfma_f32_16x16x32_bf16 v[244:247], a[172:175], v[72:75], v[244:247]
  s_waitcnt lgkmcnt(15)
  v_mfma_f32_16x16x32_bf16 v[88:91], a[112:115], a[0:3], v[52:55]
  v_exp_f32 v80, v80
  v_mfma_f32_16x16x32_bf16 v[92:95], a[128:131], a[0:3], v[52:55]
  v_mfma_f32_16x16x32_bf16 v[88:91], a[116:119], a[4:7], v[88:91]
  v_exp_f32 v81, v81
  v_mfma_f32_16x16x32_bf16 v[92:95], a[132:135], a[4:7], v[92:95]
  v_cvt_pk_bf16_f32 v72, v80, v81
  v_mfma_f32_16x16x32_bf16 v[88:91], a[120:123], a[8:11], v[88:91]
  v_exp_f32 v82, v82
  v_mfma_f32_16x16x32_bf16 v[92:95], a[136:139], a[8:11], v[92:95]
  v_mfma_f32_16x16x32_bf16 v[88:91], a[124:127], a[12:15], v[88:91]
  v_exp_f32 v83, v83
  v_mfma_f32_16x16x32_bf16 v[92:95], a[140:143], a[12:15], v[92:95]
  v_cvt_pk_bf16_f32 v73, v82, v83
  v_mfma_f32_16x16x32_bf16 a[220:223], a[228:231], v[76:79], a[220:223]
  v_exp_f32 v84, v84
  v_mfma_f32_16x16x32_bf16 v[108:111], a[144:147], v[76:79], v[108:111]
  v_mfma_f32_16x16x32_bf16 v[128:131], a[148:151], v[76:79], v[128:131]
  v_exp_f32 v85, v85
  v_mfma_f32_16x16x32_bf16 v[148:151], a[152:155], v[76:79], v[148:151]
  v_cvt_pk_bf16_f32 v74, v84, v85
  v_mfma_f32_16x16x32_bf16 v[168:171], a[156:159], v[76:79], v[168:171]
  v_exp_f32 v86, v86
  v_mfma_f32_16x16x32_bf16 v[188:191], a[160:163], v[76:79], v[188:191]
  v_mfma_f32_16x16x32_bf16 v[208:211], a[164:167], v[76:79], v[208:211]
  v_exp_f32 v87, v87
  v_mfma_f32_16x16x32_bf16 v[228:231], a[168:171], v[76:79], v[228:231]
  v_cvt_pk_bf16_f32 v75, v86, v87
  v_mfma_f32_16x16x32_bf16 v[248:251], a[172:175], v[76:79], v[248:251]
  s_waitcnt vmcnt(16) lgkmcnt(0)
  s_barrier
  v_mfma_f32_16x16x32_bf16 v[80:83], a[112:115], a[16:19], v[56:59]
  v_exp_f32 v88, v88
  v_mfma_f32_16x16x32_bf16 v[84:87], a[128:131], a[16:19], v[56:59]
  s_add_u32 m0, s39, 16384
  ds_read_b128 a[80:83], v36 offset:32768
  v_mfma_f32_16x16x32_bf16 v[80:83], a[116:119], a[20:23], v[80:83]
  v_exp_f32 v89, v89
  v_mfma_f32_16x16x32_bf16 v[84:87], a[132:135], a[20:23], v[84:87]
  v_cvt_pk_bf16_f32 v76, v88, v89
  buffer_load_dwordx4 v48, s[12:15], s36 offen offset:0 nt lds
  v_mfma_f32_16x16x32_bf16 v[80:83], a[120:123], a[24:27], v[80:83]
  v_exp_f32 v90, v90
  v_mfma_f32_16x16x32_bf16 v[84:87], a[136:139], a[24:27], v[84:87]
  ds_read_b128 a[96:99], v36 offset:36864
  ds_read_b128 a[84:87], v37 offset:32768
  v_mfma_f32_16x16x32_bf16 v[80:83], a[124:127], a[28:31], v[80:83]
  v_exp_f32 v91, v91
  v_mfma_f32_16x16x32_bf16 v[84:87], a[140:143], a[28:31], v[84:87]
  v_cvt_pk_bf16_f32 v77, v90, v91
  buffer_load_dwordx4 v49, s[12:15], s36 offen offset:1024 nt lds
  v_mfma_f32_16x16x32_bf16 a[224:227], a[228:231], v[72:75], a[224:227]
  v_exp_f32 v92, v92
  v_mfma_f32_16x16x32_bf16 v[112:115], a[144:147], v[72:75], v[112:115]
  ds_read_b128 a[100:103], v37 offset:36864
  ds_read_b128 a[88:91], v38 offset:32768
  v_mfma_f32_16x16x32_bf16 v[132:135], a[148:151], v[72:75], v[132:135]
  v_exp_f32 v93, v93
  v_mfma_f32_16x16x32_bf16 v[152:155], a[152:155], v[72:75], v[152:155]
  v_cvt_pk_bf16_f32 v78, v92, v93
  buffer_load_dwordx4 v50, s[12:15], s36 offen offset:2048 nt lds
  v_mfma_f32_16x16x32_bf16 v[172:175], a[156:159], v[72:75], v[172:175]
  v_exp_f32 v94, v94
  v_mfma_f32_16x16x32_bf16 v[192:195], a[160:163], v[72:75], v[192:195]
  ds_read_b128 a[104:107], v38 offset:36864
  ds_read_b128 a[92:95], v39 offset:32768
  v_mfma_f32_16x16x32_bf16 v[212:215], a[164:167], v[72:75], v[212:215]
  v_exp_f32 v95, v95
  v_mfma_f32_16x16x32_bf16 v[232:235], a[168:171], v[72:75], v[232:235]
  v_cvt_pk_bf16_f32 v79, v94, v95
  buffer_load_dwordx4 v51, s[12:15], s36 offen offset:3072 nt lds
  v_mfma_f32_16x16x32_bf16 v[252:255], a[172:175], v[72:75], v[252:255]
  s_add_u32 s36, s36, 4096
  ds_read_b128 a[108:111], v39 offset:36864
  v_mfma_f32_16x16x32_bf16 v[88:91], a[112:115], a[32:35], v[60:63]
  v_exp_f32 v80, v80
  v_mfma_f32_16x16x32_bf16 v[92:95], a[128:131], a[32:35], v[60:63]
  s_add_u32 m0, s39, 20480
  ds_read_b64_tr_b16 a[144:145], v40 offset:32768
  v_mfma_f32_16x16x32_bf16 v[88:91], a[116:119], a[36:39], v[88:91]
  v_exp_f32 v81, v81
  v_mfma_f32_16x16x32_bf16 v[92:95], a[132:135], a[36:39], v[92:95]
  v_cvt_pk_bf16_f32 v72, v80, v81
  buffer_load_dwordx4 v48, s[12:15], s36 offen offset:0 nt lds
  v_mfma_f32_16x16x32_bf16 v[88:91], a[120:123], a[40:43], v[88:91]
  v_exp_f32 v82, v82
  v_mfma_f32_16x16x32_bf16 v[92:95], a[136:139], a[40:43], v[92:95]
  ds_read_b64_tr_b16 a[146:147], v40 offset:36864
  ds_read_b64_tr_b16 a[148:149], v41 offset:32768
  v_mfma_f32_16x16x32_bf16 v[88:91], a[124:127], a[44:47], v[88:91]
  v_exp_f32 v83, v83
  v_mfma_f32_16x16x32_bf16 v[92:95], a[140:143], a[44:47], v[92:95]
  v_cvt_pk_bf16_f32 v73, v82, v83
  buffer_load_dwordx4 v49, s[12:15], s36 offen offset:1024 nt lds
  v_mfma_f32_16x16x32_bf16 a[208:211], a[228:231], v[76:79], a[208:211]
  v_exp_f32 v84, v84
  v_mfma_f32_16x16x32_bf16 v[96:99], a[176:179], v[76:79], v[96:99]
  ds_read_b64_tr_b16 a[150:151], v41 offset:36864
  ds_read_b64_tr_b16 a[152:153], v42 offset:32768
  v_mfma_f32_16x16x32_bf16 v[116:119], a[180:183], v[76:79], v[116:119]
  v_exp_f32 v85, v85
  v_mfma_f32_16x16x32_bf16 v[136:139], a[184:187], v[76:79], v[136:139]
  v_cvt_pk_bf16_f32 v74, v84, v85
  buffer_load_dwordx4 v50, s[12:15], s36 offen offset:2048 nt lds
  v_mfma_f32_16x16x32_bf16 v[156:159], a[188:191], v[76:79], v[156:159]
  v_exp_f32 v86, v86
  v_mfma_f32_16x16x32_bf16 v[176:179], a[192:195], v[76:79], v[176:179]
  ds_read_b64_tr_b16 a[154:155], v42 offset:36864
  v_mfma_f32_16x16x32_bf16 v[196:199], a[196:199], v[76:79], v[196:199]
  v_exp_f32 v87, v87
  v_mfma_f32_16x16x32_bf16 v[216:219], a[200:203], v[76:79], v[216:219]
  v_cvt_pk_bf16_f32 v75, v86, v87
  v_mfma_f32_16x16x32_bf16 v[236:239], a[204:207], v[76:79], v[236:239]
  v_mfma_f32_16x16x32_bf16 v[80:83], a[112:115], a[48:51], v[64:67]
  v_exp_f32 v88, v88
  v_mfma_f32_16x16x32_bf16 v[84:87], a[128:131], a[48:51], v[64:67]
  buffer_load_dwordx4 v51, s[12:15], s36 offen offset:3072 nt lds
  ds_read_b64_tr_b16 a[156:157], v43 offset:32768
  v_mfma_f32_16x16x32_bf16 v[80:83], a[116:119], a[52:55], v[80:83]
  v_exp_f32 v89, v89
  v_mfma_f32_16x16x32_bf16 v[84:87], a[132:135], a[52:55], v[84:87]
  v_cvt_pk_bf16_f32 v76, v88, v89
  s_add_u32 s36, s36, 4096
  v_mfma_f32_16x16x32_bf16 v[80:83], a[120:123], a[56:59], v[80:83]
  v_exp_f32 v90, v90
  v_mfma_f32_16x16x32_bf16 v[84:87], a[136:139], a[56:59], v[84:87]
  ds_read_b64_tr_b16 a[158:159], v43 offset:36864
  ds_read_b64_tr_b16 a[160:161], v44 offset:32768
  v_mfma_f32_16x16x32_bf16 v[80:83], a[124:127], a[60:63], v[80:83]
  v_exp_f32 v91, v91
  v_mfma_f32_16x16x32_bf16 v[84:87], a[140:143], a[60:63], v[84:87]
  v_cvt_pk_bf16_f32 v77, v90, v91
  ds_read_b64_tr_b16 a[162:163], v44 offset:36864
  v_mfma_f32_16x16x32_bf16 a[212:215], a[228:231], v[72:75], a[212:215]
  v_exp_f32 v92, v92
  v_mfma_f32_16x16x32_bf16 v[100:103], a[176:179], v[72:75], v[100:103]
  ds_read_b64_tr_b16 a[164:165], v45 offset:32768
  v_mfma_f32_16x16x32_bf16 v[120:123], a[180:183], v[72:75], v[120:123]
  v_exp_f32 v93, v93
  v_mfma_f32_16x16x32_bf16 v[140:143], a[184:187], v[72:75], v[140:143]
  v_cvt_pk_bf16_f32 v78, v92, v93
  v_mfma_f32_16x16x32_bf16 v[160:163], a[188:191], v[72:75], v[160:163]
  v_exp_f32 v94, v94
  v_mfma_f32_16x16x32_bf16 v[180:183], a[192:195], v[72:75], v[180:183]
  v_mfma_f32_16x16x32_bf16 v[200:203], a[196:199], v[72:75], v[200:203]
  v_exp_f32 v95, v95
  v_mfma_f32_16x16x32_bf16 v[220:223], a[200:203], v[72:75], v[220:223]
  v_cvt_pk_bf16_f32 v79, v94, v95
  v_mfma_f32_16x16x32_bf16 v[240:243], a[204:207], v[72:75], v[240:243]
  v_mfma_f32_16x16x32_bf16 v[88:91], a[112:115], a[64:67], v[68:71]
  v_exp_f32 v80, v80
  v_mfma_f32_16x16x32_bf16 v[92:95], a[128:131], a[64:67], v[68:71]
  ds_read_b64_tr_b16 a[166:167], v45 offset:36864
  ds_read_b64_tr_b16 a[168:169], v46 offset:32768
  v_mfma_f32_16x16x32_bf16 v[88:91], a[116:119], a[68:71], v[88:91]
  v_exp_f32 v81, v81
  v_mfma_f32_16x16x32_bf16 v[92:95], a[132:135], a[68:71], v[92:95]
  v_cvt_pk_bf16_f32 v72, v80, v81
  ds_read_b64_tr_b16 a[170:171], v46 offset:36864
  v_mfma_f32_16x16x32_bf16 v[88:91], a[120:123], a[72:75], v[88:91]
  v_exp_f32 v82, v82
  v_mfma_f32_16x16x32_bf16 v[92:95], a[136:139], a[72:75], v[92:95]
  ds_read_b64_tr_b16 a[172:173], v47 offset:32768
  ds_read_b64_tr_b16 a[174:175], v47 offset:36864
  v_mfma_f32_16x16x32_bf16 v[88:91], a[124:127], a[76:79], v[88:91]
  v_exp_f32 v83, v83
  v_mfma_f32_16x16x32_bf16 v[92:95], a[140:143], a[76:79], v[92:95]
  v_cvt_pk_bf16_f32 v73, v82, v83
  v_mfma_f32_16x16x32_bf16 a[216:219], a[228:231], v[76:79], a[216:219]
  v_exp_f32 v84, v84
  v_mfma_f32_16x16x32_bf16 v[104:107], a[176:179], v[76:79], v[104:107]
  v_mfma_f32_16x16x32_bf16 v[124:127], a[180:183], v[76:79], v[124:127]
  v_exp_f32 v85, v85
  v_mfma_f32_16x16x32_bf16 v[144:147], a[184:187], v[76:79], v[144:147]
  v_cvt_pk_bf16_f32 v74, v84, v85
  v_mfma_f32_16x16x32_bf16 v[164:167], a[188:191], v[76:79], v[164:167]
  v_exp_f32 v86, v86
  v_mfma_f32_16x16x32_bf16 v[184:187], a[192:195], v[76:79], v[184:187]
  v_mfma_f32_16x16x32_bf16 v[204:207], a[196:199], v[76:79], v[204:207]
  v_exp_f32 v87, v87
  v_mfma_f32_16x16x32_bf16 v[224:227], a[200:203], v[76:79], v[224:227]
  v_cvt_pk_bf16_f32 v75, v86, v87
  v_mfma_f32_16x16x32_bf16 v[244:247], a[204:207], v[76:79], v[244:247]
  s_waitcnt lgkmcnt(15)
  v_mfma_f32_16x16x32_bf16 v[80:83], a[80:83], a[0:3], v[52:55]
  v_exp_f32 v88, v88
  v_mfma_f32_16x16x32_bf16 v[84:87], a[96:99], a[0:3], v[52:55]
  v_mfma_f32_16x16x32_bf16 v[80:83], a[84:87], a[4:7], v[80:83]
  v_exp_f32 v89, v89
  v_mfma_f32_16x16x32_bf16 v[84:87], a[100:103], a[4:7], v[84:87]
  v_cvt_pk_bf16_f32 v76, v88, v89
  v_mfma_f32_16x16x32_bf16 v[80:83], a[88:91], a[8:11], v[80:83]
  v_exp_f32 v90, v90
  v_mfma_f32_16x16x32_bf16 v[84:87], a[104:107], a[8:11], v[84:87]
  v_mfma_f32_16x16x32_bf16 v[80:83], a[92:95], a[12:15], v[80:83]
  v_exp_f32 v91, v91
  v_mfma_f32_16x16x32_bf16 v[84:87], a[108:111], a[12:15], v[84:87]
  v_cvt_pk_bf16_f32 v77, v90, v91
  v_mfma_f32_16x16x32_bf16 a[220:223], a[228:231], v[72:75], a[220:223]
  v_exp_f32 v92, v92
  v_mfma_f32_16x16x32_bf16 v[108:111], a[176:179], v[72:75], v[108:111]
  v_mfma_f32_16x16x32_bf16 v[128:131], a[180:183], v[72:75], v[128:131]
  v_exp_f32 v93, v93
  v_mfma_f32_16x16x32_bf16 v[148:151], a[184:187], v[72:75], v[148:151]
  v_cvt_pk_bf16_f32 v78, v92, v93
  v_mfma_f32_16x16x32_bf16 v[168:171], a[188:191], v[72:75], v[168:171]
  v_exp_f32 v94, v94
  v_mfma_f32_16x16x32_bf16 v[188:191], a[192:195], v[72:75], v[188:191]
  v_mfma_f32_16x16x32_bf16 v[208:211], a[196:199], v[72:75], v[208:211]
  v_exp_f32 v95, v95
  v_mfma_f32_16x16x32_bf16 v[228:231], a[200:203], v[72:75], v[228:231]
  v_cvt_pk_bf16_f32 v79, v94, v95
  v_mfma_f32_16x16x32_bf16 v[248:251], a[204:207], v[72:75], v[248:251]
  s_waitcnt vmcnt(16) lgkmcnt(0)
  s_barrier
  v_mfma_f32_16x16x32_bf16 v[88:91], a[80:83], a[16:19], v[56:59]
  v_exp_f32 v80, v80
  v_mfma_f32_16x16x32_bf16 v[92:95], a[96:99], a[16:19], v[56:59]
  s_add_u32 m0, s39, 32768
  ds_read_b128 a[112:115], v36 offset:49152
  v_mfma_f32_16x16x32_bf16 v[88:91], a[84:87], a[20:23], v[88:91]
  v_exp_f32 v81, v81
  v_mfma_f32_16x16x32_bf16 v[92:95], a[100:103], a[20:23], v[92:95]
  v_cvt_pk_bf16_f32 v72, v80, v81
  buffer_load_dwordx4 v48, s[12:15], s36 offen offset:0 nt lds
  v_mfma_f32_16x16x32_bf16 v[88:91], a[88:91], a[24:27], v[88:91]
  v_exp_f32 v82, v82
  v_mfma_f32_16x16x32_bf16 v[92:95], a[104:107], a[24:27], v[92:95]
  ds_read_b128 a[128:131], v36 offset:53248
  ds_read_b128 a[116:119], v37 offset:49152
  v_mfma_f32_16x16x32_bf16 v[88:91], a[92:95], a[28:31], v[88:91]
  v_exp_f32 v83, v83
  v_mfma_f32_16x16x32_bf16 v[92:95], a[108:111], a[28:31], v[92:95]
  v_cvt_pk_bf16_f32 v73, v82, v83
  buffer_load_dwordx4 v49, s[12:15], s36 offen offset:1024 nt lds
  v_mfma_f32_16x16x32_bf16 a[224:227], a[228:231], v[76:79], a[224:227]
  v_exp_f32 v84, v84
  v_mfma_f32_16x16x32_bf16 v[112:115], a[176:179], v[76:79], v[112:115]
  ds_read_b128 a[132:135], v37 offset:53248
  ds_read_b128 a[120:123], v38 offset:49152
  v_mfma_f32_16x16x32_bf16 v[132:135], a[180:183], v[76:79], v[132:135]
  v_exp_f32 v85, v85
  v_mfma_f32_16x16x32_bf16 v[152:155], a[184:187], v[76:79], v[152:155]
  v_cvt_pk_bf16_f32 v74, v84, v85
  buffer_load_dwordx4 v50, s[12:15], s36 offen offset:2048 nt lds
  v_mfma_f32_16x16x32_bf16 v[172:175], a[188:191], v[76:79], v[172:175]
  v_exp_f32 v86, v86
  v_mfma_f32_16x16x32_bf16 v[192:195], a[192:195], v[76:79], v[192:195]
  ds_read_b128 a[136:139], v38 offset:53248
  ds_read_b128 a[124:127], v39 offset:49152
  v_mfma_f32_16x16x32_bf16 v[212:215], a[196:199], v[76:79], v[212:215]
  v_exp_f32 v87, v87
  v_mfma_f32_16x16x32_bf16 v[232:235], a[200:203], v[76:79], v[232:235]
  v_cvt_pk_bf16_f32 v75, v86, v87
  buffer_load_dwordx4 v51, s[12:15], s36 offen offset:3072 nt lds
  v_mfma_f32_16x16x32_bf16 v[252:255], a[204:207], v[76:79], v[252:255]
  s_add_u32 s36, s36, 4096
  ds_read_b128 a[140:143], v39 offset:53248
  v_mfma_f32_16x16x32_bf16 v[80:83], a[80:83], a[32:35], v[60:63]
  v_exp_f32 v88, v88
  v_mfma_f32_16x16x32_bf16 v[84:87], a[96:99], a[32:35], v[60:63]
  s_add_u32 m0, s39, 36864
  ds_read_b64_tr_b16 a[176:177], v40 offset:49152
  v_mfma_f32_16x16x32_bf16 v[80:83], a[84:87], a[36:39], v[80:83]
  v_exp_f32 v89, v89
  v_mfma_f32_16x16x32_bf16 v[84:87], a[100:103], a[36:39], v[84:87]
  v_cvt_pk_bf16_f32 v76, v88, v89
  buffer_load_dwordx4 v48, s[12:15], s36 offen offset:0 nt lds
  v_mfma_f32_16x16x32_bf16 v[80:83], a[88:91], a[40:43], v[80:83]
  v_exp_f32 v90, v90
  v_mfma_f32_16x16x32_bf16 v[84:87], a[104:107], a[40:43], v[84:87]
  ds_read_b64_tr_b16 a[178:179], v40 offset:53248
  ds_read_b64_tr_b16 a[180:181], v41 offset:49152
  v_mfma_f32_16x16x32_bf16 v[80:83], a[92:95], a[44:47], v[80:83]
  v_exp_f32 v91, v91
  v_mfma_f32_16x16x32_bf16 v[84:87], a[108:111], a[44:47], v[84:87]
  v_cvt_pk_bf16_f32 v77, v90, v91
  buffer_load_dwordx4 v49, s[12:15], s36 offen offset:1024 nt lds
  v_mfma_f32_16x16x32_bf16 a[208:211], a[228:231], v[72:75], a[208:211]
  v_exp_f32 v92, v92
  v_mfma_f32_16x16x32_bf16 v[96:99], a[144:147], v[72:75], v[96:99]
  ds_read_b64_tr_b16 a[182:183], v41 offset:53248
  ds_read_b64_tr_b16 a[184:185], v42 offset:49152
  v_mfma_f32_16x16x32_bf16 v[116:119], a[148:151], v[72:75], v[116:119]
  v_exp_f32 v93, v93
  v_mfma_f32_16x16x32_bf16 v[136:139], a[152:155], v[72:75], v[136:139]
  v_cvt_pk_bf16_f32 v78, v92, v93
  buffer_load_dwordx4 v50, s[12:15], s36 offen offset:2048 nt lds
  v_mfma_f32_16x16x32_bf16 v[156:159], a[156:159], v[72:75], v[156:159]
  v_exp_f32 v94, v94
  v_mfma_f32_16x16x32_bf16 v[176:179], a[160:163], v[72:75], v[176:179]
  ds_read_b64_tr_b16 a[186:187], v42 offset:53248
  v_mfma_f32_16x16x32_bf16 v[196:199], a[164:167], v[72:75], v[196:199]
  v_exp_f32 v95, v95
  v_mfma_f32_16x16x32_bf16 v[216:219], a[168:171], v[72:75], v[216:219]
  v_cvt_pk_bf16_f32 v79, v94, v95
  v_mfma_f32_16x16x32_bf16 v[236:239], a[172:175], v[72:75], v[236:239]
  v_mfma_f32_16x16x32_bf16 v[88:91], a[80:83], a[48:51], v[64:67]
  v_exp_f32 v80, v80
  v_mfma_f32_16x16x32_bf16 v[92:95], a[96:99], a[48:51], v[64:67]
  buffer_load_dwordx4 v51, s[12:15], s36 offen offset:3072 nt lds
  ds_read_b64_tr_b16 a[188:189], v43 offset:49152
  v_mfma_f32_16x16x32_bf16 v[88:91], a[84:87], a[52:55], v[88:91]
  v_exp_f32 v81, v81
  v_mfma_f32_16x16x32_bf16 v[92:95], a[100:103], a[52:55], v[92:95]
  v_cvt_pk_bf16_f32 v72, v80, v81
  s_add_u32 s36, s36, 4096
  v_mfma_f32_16x16x32_bf16 v[88:91], a[88:91], a[56:59], v[88:91]
  v_exp_f32 v82, v82
  v_mfma_f32_16x16x32_bf16 v[92:95], a[104:107], a[56:59], v[92:95]
  ds_read_b64_tr_b16 a[190:191], v43 offset:53248
  ds_read_b64_tr_b16 a[192:193], v44 offset:49152
  v_mfma_f32_16x16x32_bf16 v[88:91], a[92:95], a[60:63], v[88:91]
  v_exp_f32 v83, v83
  v_mfma_f32_16x16x32_bf16 v[92:95], a[108:111], a[60:63], v[92:95]
  v_cvt_pk_bf16_f32 v73, v82, v83
  ds_read_b64_tr_b16 a[194:195], v44 offset:53248
  v_mfma_f32_16x16x32_bf16 a[212:215], a[228:231], v[76:79], a[212:215]
  v_exp_f32 v84, v84
  v_mfma_f32_16x16x32_bf16 v[100:103], a[144:147], v[76:79], v[100:103]
  ds_read_b64_tr_b16 a[196:197], v45 offset:49152
  v_mfma_f32_16x16x32_bf16 v[120:123], a[148:151], v[76:79], v[120:123]
  v_exp_f32 v85, v85
  v_mfma_f32_16x16x32_bf16 v[140:143], a[152:155], v[76:79], v[140:143]
  v_cvt_pk_bf16_f32 v74, v84, v85
  v_mfma_f32_16x16x32_bf16 v[160:163], a[156:159], v[76:79], v[160:163]
  v_exp_f32 v86, v86
  v_mfma_f32_16x16x32_bf16 v[180:183], a[160:163], v[76:79], v[180:183]
  v_mfma_f32_16x16x32_bf16 v[200:203], a[164:167], v[76:79], v[200:203]
  v_exp_f32 v87, v87
  v_mfma_f32_16x16x32_bf16 v[220:223], a[168:171], v[76:79], v[220:223]
  v_cvt_pk_bf16_f32 v75, v86, v87
  v_mfma_f32_16x16x32_bf16 v[240:243], a[172:175], v[76:79], v[240:243]
  v_mfma_f32_16x16x32_bf16 v[80:83], a[80:83], a[64:67], v[68:71]
  v_exp_f32 v88, v88
  v_mfma_f32_16x16x32_bf16 v[84:87], a[96:99], a[64:67], v[68:71]
  ds_read_b64_tr_b16 a[198:199], v45 offset:53248
  ds_read_b64_tr_b16 a[200:201], v46 offset:49152
  v_mfma_f32_16x16x32_bf16 v[80:83], a[84:87], a[68:71], v[80:83]
  v_exp_f32 v89, v89
  v_mfma_f32_16x16x32_bf16 v[84:87], a[100:103], a[68:71], v[84:87]
  v_cvt_pk_bf16_f32 v76, v88, v89
  ds_read_b64_tr_b16 a[202:203], v46 offset:53248
  v_mfma_f32_16x16x32_bf16 v[80:83], a[88:91], a[72:75], v[80:83]
  v_exp_f32 v90, v90
  v_mfma_f32_16x16x32_bf16 v[84:87], a[104:107], a[72:75], v[84:87]
  ds_read_b64_tr_b16 a[204:205], v47 offset:49152
  ds_read_b64_tr_b16 a[206:207], v47 offset:53248
  v_mfma_f32_16x16x32_bf16 v[80:83], a[92:95], a[76:79], v[80:83]
  v_exp_f32 v91, v91
  v_mfma_f32_16x16x32_bf16 v[84:87], a[108:111], a[76:79], v[84:87]
  v_cvt_pk_bf16_f32 v77, v90, v91
  v_mfma_f32_16x16x32_bf16 a[216:219], a[228:231], v[72:75], a[216:219]
  v_exp_f32 v92, v92
  v_mfma_f32_16x16x32_bf16 v[104:107], a[144:147], v[72:75], v[104:107]
  v_mfma_f32_16x16x32_bf16 v[124:127], a[148:151], v[72:75], v[124:127]
  v_exp_f32 v93, v93
  v_mfma_f32_16x16x32_bf16 v[144:147], a[152:155], v[72:75], v[144:147]
  v_cvt_pk_bf16_f32 v78, v92, v93
  v_mfma_f32_16x16x32_bf16 v[164:167], a[156:159], v[72:75], v[164:167]
  v_exp_f32 v94, v94
  v_mfma_f32_16x16x32_bf16 v[184:187], a[160:163], v[72:75], v[184:187]
  v_mfma_f32_16x16x32_bf16 v[204:207], a[164:167], v[72:75], v[204:207]
  v_exp_f32 v95, v95
  v_mfma_f32_16x16x32_bf16 v[224:227], a[168:171], v[72:75], v[224:227]
  v_cvt_pk_bf16_f32 v79, v94, v95
  v_mfma_f32_16x16x32_bf16 v[244:247], a[172:175], v[72:75], v[244:247]
  s_waitcnt lgkmcnt(15)
  v_mfma_f32_16x16x32_bf16 v[88:91], a[112:115], a[0:3], v[52:55]
  v_exp_f32 v80, v80
  v_mfma_f32_16x16x32_bf16 v[92:95], a[128:131], a[0:3], v[52:55]
  v_mfma_f32_16x16x32_bf16 v[88:91], a[116:119], a[4:7], v[88:91]
  v_exp_f32 v81, v81
  v_mfma_f32_16x16x32_bf16 v[92:95], a[132:135], a[4:7], v[92:95]
  v_cvt_pk_bf16_f32 v72, v80, v81
  v_mfma_f32_16x16x32_bf16 v[88:91], a[120:123], a[8:11], v[88:91]
  v_exp_f32 v82, v82
  v_mfma_f32_16x16x32_bf16 v[92:95], a[136:139], a[8:11], v[92:95]
  v_mfma_f32_16x16x32_bf16 v[88:91], a[124:127], a[12:15], v[88:91]
  v_exp_f32 v83, v83
  v_mfma_f32_16x16x32_bf16 v[92:95], a[140:143], a[12:15], v[92:95]
  v_cvt_pk_bf16_f32 v73, v82, v83
  v_mfma_f32_16x16x32_bf16 a[220:223], a[228:231], v[76:79], a[220:223]
  v_exp_f32 v84, v84
  v_mfma_f32_16x16x32_bf16 v[108:111], a[144:147], v[76:79], v[108:111]
  v_mfma_f32_16x16x32_bf16 v[128:131], a[148:151], v[76:79], v[128:131]
  v_exp_f32 v85, v85
  v_mfma_f32_16x16x32_bf16 v[148:151], a[152:155], v[76:79], v[148:151]
  v_cvt_pk_bf16_f32 v74, v84, v85
  v_mfma_f32_16x16x32_bf16 v[168:171], a[156:159], v[76:79], v[168:171]
  v_exp_f32 v86, v86
  v_mfma_f32_16x16x32_bf16 v[188:191], a[160:163], v[76:79], v[188:191]
  v_mfma_f32_16x16x32_bf16 v[208:211], a[164:167], v[76:79], v[208:211]
  v_exp_f32 v87, v87
  v_mfma_f32_16x16x32_bf16 v[228:231], a[168:171], v[76:79], v[228:231]
  v_cvt_pk_bf16_f32 v75, v86, v87
  v_mfma_f32_16x16x32_bf16 v[248:251], a[172:175], v[76:79], v[248:251]
  s_waitcnt vmcnt(16) lgkmcnt(0)
  s_barrier
  v_mfma_f32_16x16x32_bf16 v[80:83], a[112:115], a[16:19], v[56:59]
  v_exp_f32 v88, v88
  v_mfma_f32_16x16x32_bf16 v[84:87], a[128:131], a[16:19], v[56:59]
  s_add_u32 m0, s39, 49152
  ds_read_b128 a[80:83], v36 offset:0
  v_mfma_f32_16x16x32_bf16 v[80:83], a[116:119], a[20:23], v[80:83]
  v_exp_f32 v89, v89
  v_mfma_f32_16x16x32_bf16 v[84:87], a[132:135], a[20:23], v[84:87]
  v_cvt_pk_bf16_f32 v76, v88, v89
  buffer_load_dwordx4 v48, s[12:15], s36 offen offset:0 nt lds
  v_mfma_f32_16x16x32_bf16 v[80:83], a[120:123], a[24:27], v[80:83]
  v_exp_f32 v90, v90
  v_mfma_f32_16x16x32_bf16 v[84:87], a[136:139], a[24:27], v[84:87]
  ds_read_b128 a[96:99], v36 offset:4096
  ds_read_b128 a[84:87], v37 offset:0
  v_mfma_f32_16x16x32_bf16 v[80:83], a[124:127], a[28:31], v[80:83]
  v_exp_f32 v91, v91
  v_mfma_f32_16x16x32_bf16 v[84:87], a[140:143], a[28:31], v[84:87]
  v_cvt_pk_bf16_f32 v77, v90, v91
  buffer_load_dwordx4 v49, s[12:15], s36 offen offset:1024 nt lds
  v_mfma_f32_16x16x32_bf16 a[224:227], a[228:231], v[72:75], a[224:227]
  v_exp_f32 v92, v92
  v_mfma_f32_16x16x32_bf16 v[112:115], a[144:147], v[72:75], v[112:115]
  ds_read_b128 a[100:103], v37 offset:4096
  ds_read_b128 a[88:91], v38 offset:0
  v_mfma_f32_16x16x32_bf16 v[132:135], a[148:151], v[72:75], v[132:135]
  v_exp_f32 v93, v93
  v_mfma_f32_16x16x32_bf16 v[152:155], a[152:155], v[72:75], v[152:155]
  v_cvt_pk_bf16_f32 v78, v92, v93
  buffer_load_dwordx4 v50, s[12:15], s36 offen offset:2048 nt lds
  v_mfma_f32_16x16x32_bf16 v[172:175], a[156:159], v[72:75], v[172:175]
  v_exp_f32 v94, v94
  v_mfma_f32_16x16x32_bf16 v[192:195], a[160:163], v[72:75], v[192:195]
  ds_read_b128 a[104:107], v38 offset:4096
  ds_read_b128 a[92:95], v39 offset:0
  v_mfma_f32_16x16x32_bf16 v[212:215], a[164:167], v[72:75], v[212:215]
  v_exp_f32 v95, v95
  v_mfma_f32_16x16x32_bf16 v[232:235], a[168:171], v[72:75], v[232:235]
  v_cvt_pk_bf16_f32 v79, v94, v95
  buffer_load_dwordx4 v51, s[12:15], s36 offen offset:3072 nt lds
  v_mfma_f32_16x16x32_bf16 v[252:255], a[172:175], v[72:75], v[252:255]
  s_add_u32 s36, s36, 4096
  ds_read_b128 a[108:111], v39 offset:4096
  v_mfma_f32_16x16x32_bf16 v[88:91], a[112:115], a[32:35], v[60:63]
  v_exp_f32 v80, v80
  v_mfma_f32_16x16x32_bf16 v[92:95], a[128:131], a[32:35], v[60:63]
  s_add_u32 m0, s39, 53248
  ds_read_b64_tr_b16 a[144:145], v40 offset:0
  v_mfma_f32_16x16x32_bf16 v[88:91], a[116:119], a[36:39], v[88:91]
  v_exp_f32 v81, v81
  v_mfma_f32_16x16x32_bf16 v[92:95], a[132:135], a[36:39], v[92:95]
  v_cvt_pk_bf16_f32 v72, v80, v81
  buffer_load_dwordx4 v48, s[12:15], s36 offen offset:0 nt lds
  v_mfma_f32_16x16x32_bf16 v[88:91], a[120:123], a[40:43], v[88:91]
  v_exp_f32 v82, v82
  v_mfma_f32_16x16x32_bf16 v[92:95], a[136:139], a[40:43], v[92:95]
  ds_read_b64_tr_b16 a[146:147], v40 offset:4096
  ds_read_b64_tr_b16 a[148:149], v41 offset:0
  v_mfma_f32_16x16x32_bf16 v[88:91], a[124:127], a[44:47], v[88:91]
  v_exp_f32 v83, v83
  v_mfma_f32_16x16x32_bf16 v[92:95], a[140:143], a[44:47], v[92:95]
  v_cvt_pk_bf16_f32 v73, v82, v83
  buffer_load_dwordx4 v49, s[12:15], s36 offen offset:1024 nt lds
  v_mfma_f32_16x16x32_bf16 a[208:211], a[228:231], v[76:79], a[208:211]
  v_exp_f32 v84, v84
  v_mfma_f32_16x16x32_bf16 v[96:99], a[176:179], v[76:79], v[96:99]
  ds_read_b64_tr_b16 a[150:151], v41 offset:4096
  ds_read_b64_tr_b16 a[152:153], v42 offset:0
  v_mfma_f32_16x16x32_bf16 v[116:119], a[180:183], v[76:79], v[116:119]
  v_exp_f32 v85, v85
  v_mfma_f32_16x16x32_bf16 v[136:139], a[184:187], v[76:79], v[136:139]
  v_cvt_pk_bf16_f32 v74, v84, v85
  buffer_load_dwordx4 v50, s[12:15], s36 offen offset:2048 nt lds
  v_mfma_f32_16x16x32_bf16 v[156:159], a[188:191], v[76:79], v[156:159]
  v_exp_f32 v86, v86
  v_mfma_f32_16x16x32_bf16 v[176:179], a[192:195], v[76:79], v[176:179]
  ds_read_b64_tr_b16 a[154:155], v42 offset:4096
  v_mfma_f32_16x16x32_bf16 v[196:199], a[196:199], v[76:79], v[196:199]
  v_exp_f32 v87, v87
  v_mfma_f32_16x16x32_bf16 v[216:219], a[200:203], v[76:79], v[216:219]
  v_cvt_pk_bf16_f32 v75, v86, v87
  v_mfma_f32_16x16x32_bf16 v[236:239], a[204:207], v[76:79], v[236:239]
  v_mfma_f32_16x16x32_bf16 v[80:83], a[112:115], a[48:51], v[64:67]
  v_exp_f32 v88, v88
  v_mfma_f32_16x16x32_bf16 v[84:87], a[128:131], a[48:51], v[64:67]
  buffer_load_dwordx4 v51, s[12:15], s36 offen offset:3072 nt lds
  ds_read_b64_tr_b16 a[156:157], v43 offset:0
  v_mfma_f32_16x16x32_bf16 v[80:83], a[116:119], a[52:55], v[80:83]
  v_exp_f32 v89, v89
  v_mfma_f32_16x16x32_bf16 v[84:87], a[132:135], a[52:55], v[84:87]
  v_cvt_pk_bf16_f32 v76, v88, v89
  s_add_u32 s36, s36, 4096
  v_mfma_f32_16x16x32_bf16 v[80:83], a[120:123], a[56:59], v[80:83]
  v_exp_f32 v90, v90
  v_mfma_f32_16x16x32_bf16 v[84:87], a[136:139], a[56:59], v[84:87]
  ds_read_b64_tr_b16 a[158:159], v43 offset:4096
  ds_read_b64_tr_b16 a[160:161], v44 offset:0
  v_mfma_f32_16x16x32_bf16 v[80:83], a[124:127], a[60:63], v[80:83]
  v_exp_f32 v91, v91
  v_mfma_f32_16x16x32_bf16 v[84:87], a[140:143], a[60:63], v[84:87]
  v_cvt_pk_bf16_f32 v77, v90, v91
  ds_read_b64_tr_b16 a[162:163], v44 offset:4096
  v_mfma_f32_16x16x32_bf16 a[212:215], a[228:231], v[72:75], a[212:215]
  v_exp_f32 v92, v92
  v_mfma_f32_16x16x32_bf16 v[100:103], a[176:179], v[72:75], v[100:103]
  ds_read_b64_tr_b16 a[164:165], v45 offset:0
  v_mfma_f32_16x16x32_bf16 v[120:123], a[180:183], v[72:75], v[120:123]
  v_exp_f32 v93, v93
  v_mfma_f32_16x16x32_bf16 v[140:143], a[184:187], v[72:75], v[140:143]
  v_cvt_pk_bf16_f32 v78, v92, v93
  v_mfma_f32_16x16x32_bf16 v[160:163], a[188:191], v[72:75], v[160:163]
  v_exp_f32 v94, v94
  v_mfma_f32_16x16x32_bf16 v[180:183], a[192:195], v[72:75], v[180:183]
  v_mfma_f32_16x16x32_bf16 v[200:203], a[196:199], v[72:75], v[200:203]
  v_exp_f32 v95, v95
  v_mfma_f32_16x16x32_bf16 v[220:223], a[200:203], v[72:75], v[220:223]
  v_cvt_pk_bf16_f32 v79, v94, v95
  v_mfma_f32_16x16x32_bf16 v[240:243], a[204:207], v[72:75], v[240:243]
  v_mfma_f32_16x16x32_bf16 v[88:91], a[112:115], a[64:67], v[68:71]
  v_exp_f32 v80, v80
  v_mfma_f32_16x16x32_bf16 v[92:95], a[128:131], a[64:67], v[68:71]
  ds_read_b64_tr_b16 a[166:167], v45 offset:4096
  ds_read_b64_tr_b16 a[168:169], v46 offset:0
  v_mfma_f32_16x16x32_bf16 v[88:91], a[116:119], a[68:71], v[88:91]
  v_exp_f32 v81, v81
  v_mfma_f32_16x16x32_bf16 v[92:95], a[132:135], a[68:71], v[92:95]
  v_cvt_pk_bf16_f32 v72, v80, v81
  ds_read_b64_tr_b16 a[170:171], v46 offset:4096
  v_mfma_f32_16x16x32_bf16 v[88:91], a[120:123], a[72:75], v[88:91]
  v_exp_f32 v82, v82
  v_mfma_f32_16x16x32_bf16 v[92:95], a[136:139], a[72:75], v[92:95]
  ds_read_b64_tr_b16 a[172:173], v47 offset:0
  ds_read_b64_tr_b16 a[174:175], v47 offset:4096
  v_mfma_f32_16x16x32_bf16 v[88:91], a[124:127], a[76:79], v[88:91]
  v_exp_f32 v83, v83
  v_mfma_f32_16x16x32_bf16 v[92:95], a[140:143], a[76:79], v[92:95]
  v_cvt_pk_bf16_f32 v73, v82, v83
  v_mfma_f32_16x16x32_bf16 a[216:219], a[228:231], v[76:79], a[216:219]
  v_exp_f32 v84, v84
  v_mfma_f32_16x16x32_bf16 v[104:107], a[176:179], v[76:79], v[104:107]
  v_mfma_f32_16x16x32_bf16 v[124:127], a[180:183], v[76:79], v[124:127]
  v_exp_f32 v85, v85
  v_mfma_f32_16x16x32_bf16 v[144:147], a[184:187], v[76:79], v[144:147]
  v_cvt_pk_bf16_f32 v74, v84, v85
  v_mfma_f32_16x16x32_bf16 v[164:167], a[188:191], v[76:79], v[164:167]
  v_exp_f32 v86, v86
  v_mfma_f32_16x16x32_bf16 v[184:187], a[192:195], v[76:79], v[184:187]
  v_mfma_f32_16x16x32_bf16 v[204:207], a[196:199], v[76:79], v[204:207]
  v_exp_f32 v87, v87
  v_mfma_f32_16x16x32_bf16 v[224:227], a[200:203], v[76:79], v[224:227]
  v_cvt_pk_bf16_f32 v75, v86, v87
  v_mfma_f32_16x16x32_bf16 v[244:247], a[204:207], v[76:79], v[244:247]
  s_waitcnt lgkmcnt(15)
  v_mfma_f32_16x16x32_bf16 v[80:83], a[80:83], a[0:3], v[52:55]
  v_exp_f32 v88, v88
  v_mfma_f32_16x16x32_bf16 v[84:87], a[96:99], a[0:3], v[52:55]
  v_mfma_f32_16x16x32_bf16 v[80:83], a[84:87], a[4:7], v[80:83]
  v_exp_f32 v89, v89
  v_mfma_f32_16x16x32_bf16 v[84:87], a[100:103], a[4:7], v[84:87]
  v_cvt_pk_bf16_f32 v76, v88, v89
  v_mfma_f32_16x16x32_bf16 v[80:83], a[88:91], a[8:11], v[80:83]
  v_exp_f32 v90, v90
  v_mfma_f32_16x16x32_bf16 v[84:87], a[104:107], a[8:11], v[84:87]
  v_mfma_f32_16x16x32_bf16 v[80:83], a[92:95], a[12:15], v[80:83]
  v_exp_f32 v91, v91
  v_mfma_f32_16x16x32_bf16 v[84:87], a[108:111], a[12:15], v[84:87]
  v_cvt_pk_bf16_f32 v77, v90, v91
  v_mfma_f32_16x16x32_bf16 a[220:223], a[228:231], v[72:75], a[220:223]
  v_exp_f32 v92, v92
  v_mfma_f32_16x16x32_bf16 v[108:111], a[176:179], v[72:75], v[108:111]
  v_mfma_f32_16x16x32_bf16 v[128:131], a[180:183], v[72:75], v[128:131]
  v_exp_f32 v93, v93
  v_mfma_f32_16x16x32_bf16 v[148:151], a[184:187], v[72:75], v[148:151]
  v_cvt_pk_bf16_f32 v78, v92, v93
  v_mfma_f32_16x16x32_bf16 v[168:171], a[188:191], v[72:75], v[168:171]
  v_exp_f32 v94, v94
  v_mfma_f32_16x16x32_bf16 v[188:191], a[192:195], v[72:75], v[188:191]
  v_mfma_f32_16x16x32_bf16 v[208:211], a[196:199], v[72:75], v[208:211]
  v_exp_f32 v95, v95
  v_mfma_f32_16x16x32_bf16 v[228:231], a[200:203], v[72:75], v[228:231]
  v_cvt_pk_bf16_f32 v79, v94, v95
  v_mfma_f32_16x16x32_bf16 v[248:251], a[204:207], v[72:75], v[248:251]
  s_add_u32 s40, s40, 1
  s_cmp_lt_u32 s40, 8
  s_waitcnt vmcnt(16) lgkmcnt(0)
  s_barrier
  s_cbranch_scc1 ATT_loop
  v_mfma_f32_16x16x32_bf16 a[224:227], a[228:231], v[76:79], a[224:227]
  v_mfma_f32_16x16x32_bf16 v[112:115], a[176:179], v[76:79], v[112:115]
  v_mfma_f32_16x16x32_bf16 v[132:135], a[180:183], v[76:79], v[132:135]
  v_mfma_f32_16x16x32_bf16 v[152:155], a[184:187], v[76:79], v[152:155]
  v_mfma_f32_16x16x32_bf16 v[172:175], a[188:191], v[76:79], v[172:175]
  v_mfma_f32_16x16x32_bf16 v[192:195], a[192:195], v[76:79], v[192:195]
  v_mfma_f32_16x16x32_bf16 v[212:215], a[196:199], v[76:79], v[212:215]
  v_mfma_f32_16x16x32_bf16 v[232:235], a[200:203], v[76:79], v[232:235]
  v_mfma_f32_16x16x32_bf16 v[252:255], a[204:207], v[76:79], v[252:255]
  s_nop 7
  s_nop 1
  v_accvgpr_read_b32 v20, a208
  v_accvgpr_read_b32 v21, a212
  v_accvgpr_read_b32 v22, a216
  v_accvgpr_read_b32 v23, a220
  v_accvgpr_read_b32 v24, a224
  v_mov_b32 v27, 1233125376
  s_mov_b64 s[74:75], 0
  v_cmp_nle_f32 vcc, 1.0, v20
  v_cmp_nlt_f32 s[76:77], v20, v27
  s_nop 1
  s_or_b64 s[74:75], s[74:75], vcc
  s_or_b64 s[74:75], s[74:75], s[76:77]
  v_cmp_nle_f32 vcc, 1.0, v21
  v_cmp_nlt_f32 s[76:77], v21, v27
  s_nop 1
  s_or_b64 s[74:75], s[74:75], vcc
  s_or_b64 s[74:75], s[74:75], s[76:77]
  v_cmp_nle_f32 vcc, 1.0, v22
  v_cmp_nlt_f32 s[76:77], v22, v27
  s_nop 1
  s_or_b64 s[74:75], s[74:75], vcc
  s_or_b64 s[74:75], s[74:75], s[76:77]
  v_cmp_nle_f32 vcc, 1.0, v23
  v_cmp_nlt_f32 s[76:77], v23, v27
  s_nop 1
  s_or_b64 s[74:75], s[74:75], vcc
  s_or_b64 s[74:75], s[74:75], s[76:77]
  v_cmp_nle_f32 vcc, 1.0, v24
  v_cmp_nlt_f32 s[76:77], v24, v27
  s_nop 1
  s_or_b64 s[74:75], s[74:75], vcc
  s_or_b64 s[74:75], s[74:75], s[76:77]
  s_cmp_lg_u64 s[74:75], 0
  s_cselect_b32 s45, 1, 0
  s_lshl_b32 s46, s20, 2
  s_add_u32 s46, s46, 163824
  v_mov_b32 v25, s45
  v_mov_b32 v26, s46
  ds_write_b32 v26, v25
  v_rcp_f32 v20, v20
  v_rcp_f32 v21, v21
  v_rcp_f32 v22, v22
  v_rcp_f32 v23, v23
  v_rcp_f32 v24, v24
  s_waitcnt vmcnt(0) lgkmcnt(0)
  s_cmp_lg_u32 s20, 0
  s_cbranch_scc1 O2_ciD
  s_mov_b32 s46, 0
O2_ci:
  v_readfirstlane_b32 s47, v15
  v_readfirstlane_b32 s45, v19
  s_add_u32 s46, s46, 1
  s_and_b32 s47, s47, 15
  s_bfe_u32 s45, s45, 0x40004
  s_min_u32 s47, s47, s45
  s_cmp_lg_u32 s47, 0
  s_cbranch_scc1 O2_ciD
  s_cmp_ge_u32 s46, 200000
  s_cbranch_scc1 O2_ciD
  s_sleep 8
  buffer_load_dword v15, v17, s[60:63], 0 offen sc1
  buffer_load_dword v19, v18, s[60:63], 0 offen sc1
  s_waitcnt vmcnt(0)
  s_branch O2_ci
O2_ciD:
  s_barrier
  v_mov_b32 v26, 163824
  ds_read_b128 v[28:31], v26
  s_cmp_lt_u32 s20, 2
  s_cselect_b32 s28, s4, s8
  s_cselect_b32 s29, s5, s9
  s_cselect_b32 s30, s6, s10
  s_waitcnt lgkmcnt(0)
  v_or_b32 v28, v28, v29
  v_or3_b32 v28, v28, v30, v31
  s_nop 0
  v_readfirstlane_b32 s45, v28
  s_xor_b32 s46, s37, 1
  s_nop 1
  s_and_b32 s45, s45, s46
  s_cmp_lg_u32 s45, 0
  s_cbranch_scc1 K1_FALLBACK
  s_mul_i32 s45, s22, 2048
  v_subrev_u32 v36, s45, v7
  v_subrev_u32 v37, s45, v8
  v_subrev_u32 v38, s45, v9
  s_mul_i32 s45, s22, 3072
  v_add_u32 v7, s45, v7
  v_add_u32 v8, s45, v8
  v_add_u32 v9, s45, v9
  s_lshl_b32 s45, s22, 7
  s_sub_u32 s45, 256, s45
  v_add_u32 v39, s45, v10
  v_pk_mul_f32 v[216:217], v[216:217], v[20:21] op_sel:[0,0] op_sel_hi:[1,0]
  v_pk_mul_f32 v[218:219], v[218:219], v[20:21] op_sel:[0,0] op_sel_hi:[1,0]
  v_pk_mul_f32 v[236:237], v[236:237], v[20:21] op_sel:[0,0] op_sel_hi:[1,0]
  v_pk_mul_f32 v[238:239], v[238:239], v[20:21] op_sel:[0,0] op_sel_hi:[1,0]
  v_cvt_pk_bf16_f32 v72, v216, v217
  v_cvt_pk_bf16_f32 v73, v218, v219
  v_cvt_pk_bf16_f32 v74, v236, v237
  v_cvt_pk_bf16_f32 v75, v238, v239
  s_mov_b32 s45, 30720
  buffer_store_dwordx4 v[72:75], v16, s[16:19], s45 offen sc1
  ds_write_b128 v11, v[72:75] offset:30720
  v_pk_mul_f32 v[220:221], v[220:221], v[20:21] op_sel:[0,1] op_sel_hi:[1,1]
  v_pk_mul_f32 v[222:223], v[222:223], v[20:21] op_sel:[0,1] op_sel_hi:[1,1]
  v_pk_mul_f32 v[240:241], v[240:241], v[20:21] op_sel:[0,1] op_sel_hi:[1,1]
  v_pk_mul_f32 v[242:243], v[242:243], v[20:21] op_sel:[0,1] op_sel_hi:[1,1]
  v_cvt_pk_bf16_f32 v76, v220, v221
  v_cvt_pk_bf16_f32 v77, v222, v223
  v_cvt_pk_bf16_f32 v78, v240, v241
  v_cvt_pk_bf16_f32 v79, v242, v243
  s_mov_b32 s45, 31744
  buffer_store_dwordx4 v[76:79], v16, s[16:19], s45 offen sc1
  ds_write_b128 v11, v[76:79] offset:31744
  v_pk_mul_f32 v[224:225], v[224:225], v[22:23] op_sel:[0,0] op_sel_hi:[1,0]
  v_pk_mul_f32 v[226:227], v[226:227], v[22:23] op_sel:[0,0] op_sel_hi:[1,0]
  v_pk_mul_f32 v[244:245], v[244:245], v[22:23] op_sel:[0,0] op_sel_hi:[1,0]
  v_pk_mul_f32 v[246:247], v[246:247], v[22:23] op_sel:[0,0] op_sel_hi:[1,0]
  v_cvt_pk_bf16_f32 v80, v224, v225
  v_cvt_pk_bf16_f32 v81, v226, v227
  v_cvt_pk_bf16_f32 v82, v244, v245
  v_cvt_pk_bf16_f32 v83, v246, v247
  s_mov_b32 s45, 32768
  buffer_store_dwordx4 v[80:83], v16, s[16:19], s45 offen sc1
  ds_write_b128 v11, v[80:83] offset:32768
  v_pk_mul_f32 v[228:229], v[228:229], v[22:23] op_sel:[0,1] op_sel_hi:[1,1]
  v_pk_mul_f32 v[230:231], v[230:231], v[22:23] op_sel:[0,1] op_sel_hi:[1,1]
  v_pk_mul_f32 v[248:249], v[248:249], v[22:23] op_sel:[0,1] op_sel_hi:[1,1]
  v_pk_mul_f32 v[250:251], v[250:251], v[22:23] op_sel:[0,1] op_sel_hi:[1,1]
  v_cvt_pk_bf16_f32 v84, v228, v229
  v_cvt_pk_bf16_f32 v85, v230, v231
  v_cvt_pk_bf16_f32 v86, v248, v249
  v_cvt_pk_bf16_f32 v87, v250, v251
  s_mov_b32 s45, 33792
  buffer_store_dwordx4 v[84:87], v16, s[16:19], s45 offen sc1
  ds_write_b128 v11, v[84:87] offset:33792
  v_pk_mul_f32 v[232:233], v[232:233], v[24:25] op_sel:[0,0] op_sel_hi:[1,0]
  v_pk_mul_f32 v[234:235], v[234:235], v[24:25] op_sel:[0,0] op_sel_hi:[1,0]
  v_pk_mul_f32 v[252:253], v[252:253], v[24:25] op_sel:[0,0] op_sel_hi:[1,0]
  v_pk_mul_f32 v[254:255], v[254:255], v[24:25] op_sel:[0,0] op_sel_hi:[1,0]
  v_cvt_pk_bf16_f32 v88, v232, v233
  v_cvt_pk_bf16_f32 v89, v234, v235
  v_cvt_pk_bf16_f32 v90, v252, v253
  v_cvt_pk_bf16_f32 v91, v254, v255
  s_mov_b32 s45, 34816
  buffer_store_dwordx4 v[88:91], v16, s[16:19], s45 offen sc1
  ds_write_b128 v11, v[88:91] offset:34816
  s_mul_i32 s34, s32, 36864
  s_add_u32 s32, s32, 1
  s_and_b32 s32, s32, 31
  s_add_u32 m0, s43, 0
  s_nop 0
  buffer_load_dwordx4 v3, s[8:11], s34 offen offset:0  lds
  buffer_load_dwordx4 v4, s[8:11], s34 offen offset:1024  lds
  s_mov_b32 m0, 90112
  s_nop 0
  buffer_load_dwordx4 v6, s[8:11], s34 offen  lds
  s_mul_i32 s34, s32, 36864
  s_add_u32 s32, s32, 1
  s_and_b32 s32, s32, 31
  s_add_u32 m0, s43, 9216
  s_nop 0
  buffer_load_dwordx4 v3, s[8:11], s34 offen offset:0  lds
  buffer_load_dwordx4 v4, s[8:11], s34 offen offset:1024  lds
  s_mov_b32 m0, 99328
  s_nop 0
  buffer_load_dwordx4 v6, s[8:11], s34 offen  lds
  s_mul_i32 s34, s32, 36864
  s_add_u32 s32, s32, 1
  s_and_b32 s32, s32, 31
  s_add_u32 m0, s43, 18432
  s_nop 0
  buffer_load_dwordx4 v3, s[8:11], s34 offen offset:0  lds
  buffer_load_dwordx4 v4, s[8:11], s34 offen offset:1024  lds
  s_mov_b32 m0, 108544
  s_nop 0
  buffer_load_dwordx4 v6, s[8:11], s34 offen  lds
  s_mul_i32 s34, s32, 36864
  s_add_u32 s32, s32, 1
  s_and_b32 s32, s32, 31
  s_add_u32 m0, s43, 27648
  s_nop 0
  buffer_load_dwordx4 v3, s[8:11], s34 offen offset:0  lds
  buffer_load_dwordx4 v4, s[8:11], s34 offen offset:1024  lds
  s_mov_b32 m0, 117760
  s_nop 0
  buffer_load_dwordx4 v6, s[8:11], s34 offen  lds
  v_pk_mul_f32 v[176:177], v[176:177], v[20:21] op_sel:[0,0] op_sel_hi:[1,0]
  v_pk_mul_f32 v[178:179], v[178:179], v[20:21] op_sel:[0,0] op_sel_hi:[1,0]
  v_pk_mul_f32 v[196:197], v[196:197], v[20:21] op_sel:[0,0] op_sel_hi:[1,0]
  v_pk_mul_f32 v[198:199], v[198:199], v[20:21] op_sel:[0,0] op_sel_hi:[1,0]
  v_cvt_pk_bf16_f32 v216, v176, v177
  v_cvt_pk_bf16_f32 v217, v178, v179
  v_cvt_pk_bf16_f32 v218, v196, v197
  v_cvt_pk_bf16_f32 v219, v198, v199
  s_mov_b32 s45, 20480
  buffer_store_dwordx4 v[216:219], v16, s[16:19], s45 offen sc1
  ds_write_b128 v11, v[216:219] offset:20480
  v_pk_mul_f32 v[180:181], v[180:181], v[20:21] op_sel:[0,1] op_sel_hi:[1,1]
  v_pk_mul_f32 v[182:183], v[182:183], v[20:21] op_sel:[0,1] op_sel_hi:[1,1]
  v_pk_mul_f32 v[200:201], v[200:201], v[20:21] op_sel:[0,1] op_sel_hi:[1,1]
  v_pk_mul_f32 v[202:203], v[202:203], v[20:21] op_sel:[0,1] op_sel_hi:[1,1]
  v_cvt_pk_bf16_f32 v220, v180, v181
  v_cvt_pk_bf16_f32 v221, v182, v183
  v_cvt_pk_bf16_f32 v222, v200, v201
  v_cvt_pk_bf16_f32 v223, v202, v203
  s_mov_b32 s45, 21504
  buffer_store_dwordx4 v[220:223], v16, s[16:19], s45 offen sc1
  ds_write_b128 v11, v[220:223] offset:21504
  v_pk_mul_f32 v[184:185], v[184:185], v[22:23] op_sel:[0,0] op_sel_hi:[1,0]
  v_pk_mul_f32 v[186:187], v[186:187], v[22:23] op_sel:[0,0] op_sel_hi:[1,0]
  v_pk_mul_f32 v[204:205], v[204:205], v[22:23] op_sel:[0,0] op_sel_hi:[1,0]
  v_pk_mul_f32 v[206:207], v[206:207], v[22:23] op_sel:[0,0] op_sel_hi:[1,0]
  v_cvt_pk_bf16_f32 v224, v184, v185
  v_cvt_pk_bf16_f32 v225, v186, v187
  v_cvt_pk_bf16_f32 v226, v204, v205
  v_cvt_pk_bf16_f32 v227, v206, v207
  s_mov_b32 s45, 22528
  buffer_store_dwordx4 v[224:227], v16, s[16:19], s45 offen sc1
  ds_write_b128 v11, v[224:227] offset:22528
  v_pk_mul_f32 v[188:189], v[188:189], v[22:23] op_sel:[0,1] op_sel_hi:[1,1]
  v_pk_mul_f32 v[190:191], v[190:191], v[22:23] op_sel:[0,1] op_sel_hi:[1,1]
  v_pk_mul_f32 v[208:209], v[208:209], v[22:23] op_sel:[0,1] op_sel_hi:[1,1]
  v_pk_mul_f32 v[210:211], v[210:211], v[22:23] op_sel:[0,1] op_sel_hi:[1,1]
  v_cvt_pk_bf16_f32 v228, v188, v189
  v_cvt_pk_bf16_f32 v229, v190, v191
  v_cvt_pk_bf16_f32 v230, v208, v209
  v_cvt_pk_bf16_f32 v231, v210, v211
  s_mov_b32 s45, 23552
  buffer_store_dwordx4 v[228:231], v16, s[16:19], s45 offen sc1
  ds_write_b128 v11, v[228:231] offset:23552
  v_pk_mul_f32 v[192:193], v[192:193], v[24:25] op_sel:[0,0] op_sel_hi:[1,0]
  v_pk_mul_f32 v[194:195], v[194:195], v[24:25] op_sel:[0,0] op_sel_hi:[1,0]
  v_pk_mul_f32 v[212:213], v[212:213], v[24:25] op_sel:[0,0] op_sel_hi:[1,0]
  v_pk_mul_f32 v[214:215], v[214:215], v[24:25] op_sel:[0,0] op_sel_hi:[1,0]
  v_cvt_pk_bf16_f32 v232, v192, v193
  v_cvt_pk_bf16_f32 v233, v194, v195
  v_cvt_pk_bf16_f32 v234, v212, v213
  v_cvt_pk_bf16_f32 v235, v214, v215
  s_mov_b32 s45, 24576
  buffer_store_dwordx4 v[232:235], v16, s[16:19], s45 offen sc1
  ds_write_b128 v11, v[232:235] offset:24576
  v_pk_mul_f32 v[136:137], v[136:137], v[20:21] op_sel:[0,0] op_sel_hi:[1,0]
  v_pk_mul_f32 v[138:139], v[138:139], v[20:21] op_sel:[0,0] op_sel_hi:[1,0]
  v_pk_mul_f32 v[156:157], v[156:157], v[20:21] op_sel:[0,0] op_sel_hi:[1,0]
  v_pk_mul_f32 v[158:159], v[158:159], v[20:21] op_sel:[0,0] op_sel_hi:[1,0]
  v_cvt_pk_bf16_f32 v236, v136, v137
  v_cvt_pk_bf16_f32 v237, v138, v139
  v_cvt_pk_bf16_f32 v238, v156, v157
  v_cvt_pk_bf16_f32 v239, v158, v159
  s_mov_b32 s45, 10240
  buffer_store_dwordx4 v[236:239], v16, s[16:19], s45 offen sc1
  ds_write_b128 v11, v[236:239] offset:10240
  v_pk_mul_f32 v[140:141], v[140:141], v[20:21] op_sel:[0,1] op_sel_hi:[1,1]
  v_pk_mul_f32 v[142:143], v[142:143], v[20:21] op_sel:[0,1] op_sel_hi:[1,1]
  v_pk_mul_f32 v[160:161], v[160:161], v[20:21] op_sel:[0,1] op_sel_hi:[1,1]
  v_pk_mul_f32 v[162:163], v[162:163], v[20:21] op_sel:[0,1] op_sel_hi:[1,1]
  v_cvt_pk_bf16_f32 v240, v140, v141
  v_cvt_pk_bf16_f32 v241, v142, v143
  v_cvt_pk_bf16_f32 v242, v160, v161
  v_cvt_pk_bf16_f32 v243, v162, v163
  s_mov_b32 s45, 11264
  buffer_store_dwordx4 v[240:243], v16, s[16:19], s45 offen sc1
  ds_write_b128 v11, v[240:243] offset:11264
  v_pk_mul_f32 v[144:145], v[144:145], v[22:23] op_sel:[0,0] op_sel_hi:[1,0]
  v_pk_mul_f32 v[146:147], v[146:147], v[22:23] op_sel:[0,0] op_sel_hi:[1,0]
  v_pk_mul_f32 v[164:165], v[164:165], v[22:23] op_sel:[0,0] op_sel_hi:[1,0]
  v_pk_mul_f32 v[166:167], v[166:167], v[22:23] op_sel:[0,0] op_sel_hi:[1,0]
  v_cvt_pk_bf16_f32 v244, v144, v145
  v_cvt_pk_bf16_f32 v245, v146, v147
  v_cvt_pk_bf16_f32 v246, v164, v165
  v_cvt_pk_bf16_f32 v247, v166, v167
  s_mov_b32 s45, 12288
  buffer_store_dwordx4 v[244:247], v16, s[16:19], s45 offen sc1
  ds_write_b128 v11, v[244:247] offset:12288
  v_pk_mul_f32 v[148:149], v[148:149], v[22:23] op_sel:[0,1] op_sel_hi:[1,1]
  v_pk_mul_f32 v[150:151], v[150:151], v[22:23] op_sel:[0,1] op_sel_hi:[1,1]
  v_pk_mul_f32 v[168:169], v[168:169], v[22:23] op_sel:[0,1] op_sel_hi:[1,1]
  v_pk_mul_f32 v[170:171], v[170:171], v[22:23] op_sel:[0,1] op_sel_hi:[1,1]
  v_cvt_pk_bf16_f32 v248, v148, v149
  v_cvt_pk_bf16_f32 v249, v150, v151
  v_cvt_pk_bf16_f32 v250, v168, v169
  v_cvt_pk_bf16_f32 v251, v170, v171
  s_mov_b32 s45, 13312
  buffer_store_dwordx4 v[248:251], v16, s[16:19], s45 offen sc1
  ds_write_b128 v11, v[248:251] offset:13312
  v_pk_mul_f32 v[152:153], v[152:153], v[24:25] op_sel:[0,0] op_sel_hi:[1,0]
  v_pk_mul_f32 v[154:155], v[154:155], v[24:25] op_sel:[0,0] op_sel_hi:[1,0]
  v_pk_mul_f32 v[172:173], v[172:173], v[24:25] op_sel:[0,0] op_sel_hi:[1,0]
  v_pk_mul_f32 v[174:175], v[174:175], v[24:25] op_sel:[0,0] op_sel_hi:[1,0]
  v_cvt_pk_bf16_f32 v252, v152, v153
  v_cvt_pk_bf16_f32 v253, v154, v155
  v_cvt_pk_bf16_f32 v254, v172, v173
  v_cvt_pk_bf16_f32 v255, v174, v175
  s_mov_b32 s45, 14336
  buffer_store_dwordx4 v[252:255], v16, s[16:19], s45 offen sc1
  ds_write_b128 v11, v[252:255] offset:14336
  v_pk_mul_f32 v[96:97], v[96:97], v[20:21] op_sel:[0,0] op_sel_hi:[1,0]
  v_pk_mul_f32 v[98:99], v[98:99], v[20:21] op_sel:[0,0] op_sel_hi:[1,0]
  v_pk_mul_f32 v[116:117], v[116:117], v[20:21] op_sel:[0,0] op_sel_hi:[1,0]
  v_pk_mul_f32 v[118:119], v[118:119], v[20:21] op_sel:[0,0] op_sel_hi:[1,0]
  v_cvt_pk_bf16_f32 v196, v96, v97
  v_cvt_pk_bf16_f32 v197, v98, v99
  v_cvt_pk_bf16_f32 v198, v116, v117
  v_cvt_pk_bf16_f32 v199, v118, v119
  s_mov_b32 s45, 0
  buffer_store_dwordx4 v[196:199], v16, s[16:19], s45 offen sc1
  ds_write_b128 v11, v[196:199] offset:0
  v_pk_mul_f32 v[100:101], v[100:101], v[20:21] op_sel:[0,1] op_sel_hi:[1,1]
  v_pk_mul_f32 v[102:103], v[102:103], v[20:21] op_sel:[0,1] op_sel_hi:[1,1]
  v_pk_mul_f32 v[120:121], v[120:121], v[20:21] op_sel:[0,1] op_sel_hi:[1,1]
  v_pk_mul_f32 v[122:123], v[122:123], v[20:21] op_sel:[0,1] op_sel_hi:[1,1]
  v_cvt_pk_bf16_f32 v200, v100, v101
  v_cvt_pk_bf16_f32 v201, v102, v103
  v_cvt_pk_bf16_f32 v202, v120, v121
  v_cvt_pk_bf16_f32 v203, v122, v123
  s_mov_b32 s45, 1024
  buffer_store_dwordx4 v[200:203], v16, s[16:19], s45 offen sc1
  ds_write_b128 v11, v[200:203] offset:1024
  v_pk_mul_f32 v[104:105], v[104:105], v[22:23] op_sel:[0,0] op_sel_hi:[1,0]
  v_pk_mul_f32 v[106:107], v[106:107], v[22:23] op_sel:[0,0] op_sel_hi:[1,0]
  v_pk_mul_f32 v[124:125], v[124:125], v[22:23] op_sel:[0,0] op_sel_hi:[1,0]
  v_pk_mul_f32 v[126:127], v[126:127], v[22:23] op_sel:[0,0] op_sel_hi:[1,0]
  v_cvt_pk_bf16_f32 v204, v104, v105
  v_cvt_pk_bf16_f32 v205, v106, v107
  v_cvt_pk_bf16_f32 v206, v124, v125
  v_cvt_pk_bf16_f32 v207, v126, v127
  s_mov_b32 s45, 2048
  buffer_store_dwordx4 v[204:207], v16, s[16:19], s45 offen sc1
  ds_write_b128 v11, v[204:207] offset:2048
  v_pk_mul_f32 v[108:109], v[108:109], v[22:23] op_sel:[0,1] op_sel_hi:[1,1]
  v_pk_mul_f32 v[110:111], v[110:111], v[22:23] op_sel:[0,1] op_sel_hi:[1,1]
  v_pk_mul_f32 v[128:129], v[128:129], v[22:23] op_sel:[0,1] op_sel_hi:[1,1]
  v_pk_mul_f32 v[130:131], v[130:131], v[22:23] op_sel:[0,1] op_sel_hi:[1,1]
  v_cvt_pk_bf16_f32 v208, v108, v109
  v_cvt_pk_bf16_f32 v209, v110, v111
  v_cvt_pk_bf16_f32 v210, v128, v129
  v_cvt_pk_bf16_f32 v211, v130, v131
  s_mov_b32 s45, 3072
  buffer_store_dwordx4 v[208:211], v16, s[16:19], s45 offen sc1
  ds_write_b128 v11, v[208:211] offset:3072
  v_pk_mul_f32 v[112:113], v[112:113], v[24:25] op_sel:[0,0] op_sel_hi:[1,0]
  v_pk_mul_f32 v[114:115], v[114:115], v[24:25] op_sel:[0,0] op_sel_hi:[1,0]
  v_pk_mul_f32 v[132:133], v[132:133], v[24:25] op_sel:[0,0] op_sel_hi:[1,0]
  v_pk_mul_f32 v[134:135], v[134:135], v[24:25] op_sel:[0,0] op_sel_hi:[1,0]
  v_cvt_pk_bf16_f32 v212, v112, v113
  v_cvt_pk_bf16_f32 v213, v114, v115
  v_cvt_pk_bf16_f32 v214, v132, v133
  v_cvt_pk_bf16_f32 v215, v134, v135
  s_mov_b32 s45, 4096
  buffer_store_dwordx4 v[212:215], v16, s[16:19], s45 offen sc1
  ds_write_b128 v11, v[212:215] offset:4096
  v_mfma_f32_32x32x16_bf16 v[96:111], a[232:235], a[232:235], 0
  v_mfma_f32_32x32x16_bf16 v[112:127], a[232:235], a[232:235], 0
  v_mfma_f32_32x32x16_bf16 v[128:143], a[232:235], a[232:235], 0
  v_mfma_f32_32x32x16_bf16 v[144:159], a[232:235], a[232:235], 0
  v_mfma_f32_32x32x16_bf16 v[160:175], a[232:235], a[232:235], 0
  v_mfma_f32_32x32x16_bf16 v[176:191], a[232:235], a[232:235], 0
  v_mfma_f32_16x16x32_bf16 v[192:195], a[232:235], a[232:235], 0
  s_waitcnt vmcnt(24) lgkmcnt(0)
  s_barrier
  ds_read_b128 a[0:3], v7 offset:0
  ds_read_b128 a[4:7], v7 offset:1024
  ds_read_b128 a[8:11], v36 offset:2048
  ds_read_b128 a[12:15], v36 offset:3072
  ds_read_b128 a[16:19], v36 offset:4096
  ds_read_b64_tr_b16 a[40:41], v10 offset:0
  ds_read_b64_tr_b16 a[42:43], v10 offset:4608
  ds_read_b64_tr_b16 a[44:45], v10 offset:32
  ds_read_b64_tr_b16 a[46:47], v10 offset:4640
  ds_read_b64_tr_b16 a[48:49], v10 offset:64
  ds_read_b64_tr_b16 a[50:51], v10 offset:4672
  ds_read_b64_tr_b16 a[52:53], v10 offset:96
  ds_read_b64_tr_b16 a[54:55], v10 offset:4704
  ds_read_b64_tr_b16 a[56:57], v39 offset:0
  ds_read_b64_tr_b16 a[58:59], v39 offset:4608
  s_waitcnt vmcnt(21) lgkmcnt(0)
  s_barrier
  v_mfma_f32_16x16x32_bf16 v[96:99], a[40:43], a[0:3], v[96:99]
  s_mul_i32 s34, s32, 36864
  s_add_u32 s32, s32, 1
  v_mfma_f32_16x16x32_bf16 v[100:103], a[40:43], a[4:7], v[100:103]
  s_and_b32 s32, s32, 31
  s_add_u32 m0, s43, 0
  v_mfma_f32_16x16x32_bf16 v[104:107], a[40:43], a[8:11], v[104:107]
  ds_read_b128 a[20:23], v7 offset:10240
  v_mfma_f32_16x16x32_bf16 v[108:111], a[40:43], a[12:15], v[108:111]
  buffer_load_dwordx4 v3, s[8:11], s34 offen offset:0  lds
  v_mfma_f32_16x16x32_bf16 v[112:115], a[40:43], a[16:19], v[112:115]
  ds_read_b128 a[24:27], v7 offset:11264
  v_mfma_f32_16x16x32_bf16 v[116:119], a[44:47], a[0:3], v[116:119]
  ds_read_b128 a[28:31], v36 offset:12288
  v_mfma_f32_16x16x32_bf16 v[120:123], a[44:47], a[4:7], v[120:123]
  ds_read_b128 a[32:35], v36 offset:13312
  v_mfma_f32_16x16x32_bf16 v[124:127], a[44:47], a[8:11], v[124:127]
  ds_read_b128 a[36:39], v36 offset:14336
  v_mfma_f32_16x16x32_bf16 v[128:131], a[44:47], a[12:15], v[128:131]
  ds_read_b64_tr_b16 a[60:61], v10 offset:9216
  v_mfma_f32_16x16x32_bf16 v[132:135], a[44:47], a[16:19], v[132:135]
  buffer_load_dwordx4 v4, s[8:11], s34 offen offset:1024  lds
  s_mov_b32 m0, 90112
  v_mfma_f32_16x16x32_bf16 v[136:139], a[48:51], a[0:3], v[136:139]
  ds_read_b64_tr_b16 a[62:63], v10 offset:13824
  v_mfma_f32_16x16x32_bf16 v[140:143], a[48:51], a[4:7], v[140:143]
  ds_read_b64_tr_b16 a[64:65], v10 offset:9248
  v_mfma_f32_16x16x32_bf16 v[144:147], a[48:51], a[8:11], v[144:147]
  ds_read_b64_tr_b16 a[66:67], v10 offset:13856
  v_mfma_f32_16x16x32_bf16 v[148:151], a[48:51], a[12:15], v[148:151]
  ds_read_b64_tr_b16 a[68:69], v10 offset:9280
  v_mfma_f32_16x16x32_bf16 v[152:155], a[48:51], a[16:19], v[152:155]
  ds_read_b64_tr_b16 a[70:71], v10 offset:13888
  v_mfma_f32_16x16x32_bf16 v[156:159], a[52:55], a[0:3], v[156:159]
  buffer_load_dwordx4 v6, s[8:11], s34 offen  lds
  v_mfma_f32_16x16x32_bf16 v[160:163], a[52:55], a[4:7], v[160:163]
  ds_read_b64_tr_b16 a[72:73], v10 offset:9312
  v_mfma_f32_16x16x32_bf16 v[164:167], a[52:55], a[8:11], v[164:167]
  ds_read_b64_tr_b16 a[74:75], v10 offset:13920
  v_mfma_f32_16x16x32_bf16 v[168:171], a[52:55], a[12:15], v[168:171]
  ds_read_b64_tr_b16 a[76:77], v39 offset:9216
  v_mfma_f32_16x16x32_bf16 v[172:175], a[52:55], a[16:19], v[172:175]
  ds_read_b64_tr_b16 a[78:79], v39 offset:13824
  v_mfma_f32_16x16x32_bf16 v[176:179], a[56:59], a[0:3], v[176:179]
  v_mfma_f32_16x16x32_bf16 v[180:183], a[56:59], a[4:7], v[180:183]
  v_mfma_f32_16x16x32_bf16 v[184:187], a[56:59], a[8:11], v[184:187]
  s_waitcnt vmcnt(21) lgkmcnt(0)
  s_barrier
  v_mfma_f32_16x16x32_bf16 v[96:99], a[60:63], a[20:23], v[96:99]
  s_mul_i32 s34, s32, 36864
  s_add_u32 s32, s32, 1
  v_mfma_f32_16x16x32_bf16 v[100:103], a[60:63], a[24:27], v[100:103]
  s_and_b32 s32, s32, 31
  s_add_u32 m0, s43, 9216
  v_mfma_f32_16x16x32_bf16 v[104:107], a[60:63], a[28:31], v[104:107]
  ds_read_b128 a[0:3], v7 offset:20480
  v_mfma_f32_16x16x32_bf16 v[108:111], a[60:63], a[32:35], v[108:111]
  buffer_load_dwordx4 v3, s[8:11], s34 offen offset:0  lds
  v_mfma_f32_16x16x32_bf16 v[112:115], a[60:63], a[36:39], v[112:115]
  ds_read_b128 a[4:7], v7 offset:21504
  v_mfma_f32_16x16x32_bf16 v[116:119], a[64:67], a[20:23], v[116:119]
  ds_read_b128 a[8:11], v36 offset:22528
  v_mfma_f32_16x16x32_bf16 v[120:123], a[64:67], a[24:27], v[120:123]
  ds_read_b128 a[12:15], v36 offset:23552
  v_mfma_f32_16x16x32_bf16 v[124:127], a[64:67], a[28:31], v[124:127]
  ds_read_b128 a[16:19], v36 offset:24576
  v_mfma_f32_16x16x32_bf16 v[128:131], a[64:67], a[32:35], v[128:131]
  ds_read_b64_tr_b16 a[40:41], v10 offset:18432
  v_mfma_f32_16x16x32_bf16 v[132:135], a[64:67], a[36:39], v[132:135]
  buffer_load_dwordx4 v4, s[8:11], s34 offen offset:1024  lds
  s_mov_b32 m0, 99328
  v_mfma_f32_16x16x32_bf16 v[136:139], a[68:71], a[20:23], v[136:139]
  ds_read_b64_tr_b16 a[42:43], v10 offset:23040
  v_mfma_f32_16x16x32_bf16 v[140:143], a[68:71], a[24:27], v[140:143]
  ds_read_b64_tr_b16 a[44:45], v10 offset:18464
  v_mfma_f32_16x16x32_bf16 v[144:147], a[68:71], a[28:31], v[144:147]
  ds_read_b64_tr_b16 a[46:47], v10 offset:23072
  v_mfma_f32_16x16x32_bf16 v[148:151], a[68:71], a[32:35], v[148:151]
  ds_read_b64_tr_b16 a[48:49], v10 offset:18496
  v_mfma_f32_16x16x32_bf16 v[152:155], a[68:71], a[36:39], v[152:155]
  ds_read_b64_tr_b16 a[50:51], v10 offset:23104
  v_mfma_f32_16x16x32_bf16 v[156:159], a[72:75], a[20:23], v[156:159]
  buffer_load_dwordx4 v6, s[8:11], s34 offen  lds
  v_mfma_f32_16x16x32_bf16 v[160:163], a[72:75], a[24:27], v[160:163]
  ds_read_b64_tr_b16 a[52:53], v10 offset:18528
  v_mfma_f32_16x16x32_bf16 v[164:167], a[72:75], a[28:31], v[164:167]
  ds_read_b64_tr_b16 a[54:55], v10 offset:23136
  v_mfma_f32_16x16x32_bf16 v[168:171], a[72:75], a[32:35], v[168:171]
  ds_read_b64_tr_b16 a[56:57], v39 offset:18432
  v_mfma_f32_16x16x32_bf16 v[172:175], a[72:75], a[36:39], v[172:175]
  ds_read_b64_tr_b16 a[58:59], v39 offset:23040
  v_mfma_f32_16x16x32_bf16 v[176:179], a[76:79], a[20:23], v[176:179]
  v_mfma_f32_16x16x32_bf16 v[180:183], a[76:79], a[24:27], v[180:183]
  v_mfma_f32_16x16x32_bf16 v[184:187], a[76:79], a[28:31], v[184:187]
  s_waitcnt vmcnt(0) lgkmcnt(0)
  s_barrier
  s_cmp_lg_u32 s20, 0
  s_cbranch_scc1 QS_ns
  s_add_u32 s45, s44, 0
  s_lshl_b32 s45, s45, 8
  v_mov_b32 v20, s45
  v_mov_b32 v21, 1
  v_cmp_eq_u32 vcc, 0, v1
  s_and_saveexec_b64 s[48:49], vcc
  buffer_atomic_add v21, v20, s[56:59], 0 offen sc1
  s_mov_b64 exec, s[48:49]
QS_ns:
  v_mfma_f32_16x16x32_bf16 v[96:99], a[40:43], a[0:3], v[96:99]
  s_mul_i32 s34, s32, 36864
  s_add_u32 s32, s32, 1
  v_mfma_f32_16x16x32_bf16 v[100:103], a[40:43], a[4:7], v[100:103]
  s_and_b32 s32, s32, 31
  s_add_u32 m0, s43, 18432
  v_mfma_f32_16x16x32_bf16 v[104:107], a[40:43], a[8:11], v[104:107]
  ds_read_b128 a[20:23], v7 offset:30720
  v_mfma_f32_16x16x32_bf16 v[108:111], a[40:43], a[12:15], v[108:111]
  buffer_load_dwordx4 v3, s[8:11], s34 offen offset:0  lds
  v_mfma_f32_16x16x32_bf16 v[112:115], a[40:43], a[16:19], v[112:115]
  ds_read_b128 a[24:27], v7 offset:31744
  v_mfma_f32_16x16x32_bf16 v[116:119], a[44:47], a[0:3], v[116:119]
  ds_read_b128 a[28:31], v36 offset:32768
  v_mfma_f32_16x16x32_bf16 v[120:123], a[44:47], a[4:7], v[120:123]
  ds_read_b128 a[32:35], v36 offset:33792
  v_mfma_f32_16x16x32_bf16 v[124:127], a[44:47], a[8:11], v[124:127]
  ds_read_b128 a[36:39], v36 offset:34816
  v_mfma_f32_16x16x32_bf16 v[128:131], a[44:47], a[12:15], v[128:131]
  ds_read_b64_tr_b16 a[60:61], v10 offset:27648
  v_mfma_f32_16x16x32_bf16 v[132:135], a[44:47], a[16:19], v[132:135]
  buffer_load_dwordx4 v4, s[8:11], s34 offen offset:1024  lds
  s_mov_b32 m0, 108544
  v_mfma_f32_16x16x32_bf16 v[136:139], a[48:51], a[0:3], v[136:139]
  ds_read_b64_tr_b16 a[62:63], v10 offset:32256
  v_mfma_f32_16x16x32_bf16 v[140:143], a[48:51], a[4:7], v[140:143]
  ds_read_b64_tr_b16 a[64:65], v10 offset:27680
  v_mfma_f32_16x16x32_bf16 v[144:147], a[48:51], a[8:11], v[144:147]
  ds_read_b64_tr_b16 a[66:67], v10 offset:32288
  v_mfma_f32_16x16x32_bf16 v[148:151], a[48:51], a[12:15], v[148:151]
  ds_read_b64_tr_b16 a[68:69], v10 offset:27712
  v_mfma_f32_16x16x32_bf16 v[152:155], a[48:51], a[16:19], v[152:155]
  ds_read_b64_tr_b16 a[70:71], v10 offset:32320
  v_mfma_f32_16x16x32_bf16 v[156:159], a[52:55], a[0:3], v[156:159]
  buffer_load_dwordx4 v6, s[8:11], s34 offen  lds
  v_mfma_f32_16x16x32_bf16 v[160:163], a[52:55], a[4:7], v[160:163]
  ds_read_b64_tr_b16 a[72:73], v10 offset:27744
  v_mfma_f32_16x16x32_bf16 v[164:167], a[52:55], a[8:11], v[164:167]
  ds_read_b64_tr_b16 a[74:75], v10 offset:32352
  v_mfma_f32_16x16x32_bf16 v[168:171], a[52:55], a[12:15], v[168:171]
  ds_read_b64_tr_b16 a[76:77], v39 offset:27648
  v_mfma_f32_16x16x32_bf16 v[172:175], a[52:55], a[16:19], v[172:175]
  ds_read_b64_tr_b16 a[78:79], v39 offset:32256
  v_mfma_f32_16x16x32_bf16 v[176:179], a[56:59], a[0:3], v[176:179]
  v_mfma_f32_16x16x32_bf16 v[180:183], a[56:59], a[4:7], v[180:183]
  v_mfma_f32_16x16x32_bf16 v[184:187], a[56:59], a[8:11], v[184:187]
  s_waitcnt vmcnt(6) lgkmcnt(0)
  s_barrier
  v_mfma_f32_16x16x32_bf16 v[96:99], a[60:63], a[20:23], v[96:99]
  s_mul_i32 s34, s32, 36864
  s_add_u32 s32, s32, 1
  v_mfma_f32_16x16x32_bf16 v[100:103], a[60:63], a[24:27], v[100:103]
  s_and_b32 s32, s32, 31
  s_add_u32 m0, s43, 27648
  v_mfma_f32_16x16x32_bf16 v[104:107], a[60:63], a[28:31], v[104:107]
  ds_read_b128 a[0:3], v8 offset:0
  v_mfma_f32_16x16x32_bf16 v[108:111], a[60:63], a[32:35], v[108:111]
  buffer_load_dwordx4 v3, s[8:11], s34 offen offset:0  lds
  v_mfma_f32_16x16x32_bf16 v[112:115], a[60:63], a[36:39], v[112:115]
  ds_read_b128 a[4:7], v8 offset:1024
  v_mfma_f32_16x16x32_bf16 v[116:119], a[64:67], a[20:23], v[116:119]
  ds_read_b128 a[8:11], v37 offset:2048
  v_mfma_f32_16x16x32_bf16 v[120:123], a[64:67], a[24:27], v[120:123]
  ds_read_b128 a[12:15], v37 offset:3072
  v_mfma_f32_16x16x32_bf16 v[124:127], a[64:67], a[28:31], v[124:127]
  ds_read_b128 a[16:19], v37 offset:4096
  v_mfma_f32_16x16x32_bf16 v[128:131], a[64:67], a[32:35], v[128:131]
  ds_read_b64_tr_b16 a[40:41], v10 offset:0
  v_mfma_f32_16x16x32_bf16 v[132:135], a[64:67], a[36:39], v[132:135]
  buffer_load_dwordx4 v4, s[8:11], s34 offen offset:1024  lds
  s_mov_b32 m0, 117760
  v_mfma_f32_16x16x32_bf16 v[136:139], a[68:71], a[20:23], v[136:139]
  ds_read_b64_tr_b16 a[42:43], v10 offset:4608
  v_mfma_f32_16x16x32_bf16 v[140:143], a[68:71], a[24:27], v[140:143]
  ds_read_b64_tr_b16 a[44:45], v10 offset:32
  v_mfma_f32_16x16x32_bf16 v[144:147], a[68:71], a[28:31], v[144:147]
  ds_read_b64_tr_b16 a[46:47], v10 offset:4640
  v_mfma_f32_16x16x32_bf16 v[148:151], a[68:71], a[32:35], v[148:151]
  ds_read_b64_tr_b16 a[48:49], v10 offset:64
  v_mfma_f32_16x16x32_bf16 v[152:155], a[68:71], a[36:39], v[152:155]
  ds_read_b64_tr_b16 a[50:51], v10 offset:4672
  v_mfma_f32_16x16x32_bf16 v[156:159], a[72:75], a[20:23], v[156:159]
  buffer_load_dwordx4 v6, s[8:11], s34 offen  lds
  v_mfma_f32_16x16x32_bf16 v[160:163], a[72:75], a[24:27], v[160:163]
  ds_read_b64_tr_b16 a[52:53], v10 offset:96
  v_mfma_f32_16x16x32_bf16 v[164:167], a[72:75], a[28:31], v[164:167]
  ds_read_b64_tr_b16 a[54:55], v10 offset:4704
  v_mfma_f32_16x16x32_bf16 v[168:171], a[72:75], a[32:35], v[168:171]
  ds_read_b64_tr_b16 a[56:57], v39 offset:0
  v_mfma_f32_16x16x32_bf16 v[172:175], a[72:75], a[36:39], v[172:175]
  ds_read_b64_tr_b16 a[58:59], v39 offset:4608
  v_mfma_f32_16x16x32_bf16 v[176:179], a[76:79], a[20:23], v[176:179]
  v_mfma_f32_16x16x32_bf16 v[180:183], a[76:79], a[24:27], v[180:183]
  v_mfma_f32_16x16x32_bf16 v[184:187], a[76:79], a[28:31], v[184:187]
  s_waitcnt vmcnt(6) lgkmcnt(0)
  s_cmp_lg_u32 s20, 0
  s_cbranch_scc1 QS_pd
  s_mov_b32 s46, 0
QS_pl:
  buffer_load_dword v21, v20, s[56:59], 0 offen sc1
  s_waitcnt vmcnt(0)
  v_readfirstlane_b32 s47, v21
  s_add_u32 s46, s46, 1
  s_cmp_ge_u32 s47, 4
  s_cbranch_scc1 QS_pd
  s_cmp_ge_u32 s46, 200000
  s_cbranch_scc1 QS_pd
  s_sleep 1
  s_branch QS_pl
QS_pd:
  s_barrier
  v_mfma_f32_16x16x32_bf16 v[96:99], a[40:43], a[0:3], v[96:99]
  s_mul_i32 s33, s32, 10240
  s_mul_i32 s34, s32, 36864
  v_mfma_f32_16x16x32_bf16 v[100:103], a[40:43], a[4:7], v[100:103]
  s_mul_i32 s35, s32, s41
  s_add_u32 m0, s42, 0
  v_mfma_f32_16x16x32_bf16 v[104:107], a[40:43], a[8:11], v[104:107]
  s_add_u32 s32, s32, 1
  s_and_b32 s32, s32, 31
  v_mfma_f32_16x16x32_bf16 v[108:111], a[40:43], a[12:15], v[108:111]
  buffer_load_dwordx4 v2, s[4:7], s33 offen offset:0 sc1 lds
  ds_read_b128 a[20:23], v8 offset:10240
  v_mfma_f32_16x16x32_bf16 v[112:115], a[40:43], a[16:19], v[112:115]
  ds_read_b128 a[24:27], v8 offset:11264
  v_mfma_f32_16x16x32_bf16 v[116:119], a[44:47], a[0:3], v[116:119]
  ds_read_b128 a[28:31], v37 offset:12288
  v_mfma_f32_16x16x32_bf16 v[120:123], a[44:47], a[4:7], v[120:123]
  ds_read_b128 a[32:35], v37 offset:13312
  v_mfma_f32_16x16x32_bf16 v[124:127], a[44:47], a[8:11], v[124:127]
  buffer_load_dwordx4 v2, s[4:7], s33 offen offset:1024 sc1 lds
  s_add_u32 m0, s43, 0
  v_mfma_f32_16x16x32_bf16 v[128:131], a[44:47], a[12:15], v[128:131]
  ds_read_b128 a[36:39], v37 offset:14336
  v_mfma_f32_16x16x32_bf16 v[132:135], a[44:47], a[16:19], v[132:135]
  ds_read_b64_tr_b16 a[60:61], v10 offset:9216
  v_mfma_f32_16x16x32_bf16 v[136:139], a[48:51], a[0:3], v[136:139]
  ds_read_b64_tr_b16 a[62:63], v10 offset:13824
  v_mfma_f32_16x16x32_bf16 v[140:143], a[48:51], a[4:7], v[140:143]
  buffer_load_dwordx4 v3, s[8:11], s34 offen offset:0  lds
  ds_read_b64_tr_b16 a[64:65], v10 offset:9248
  v_mfma_f32_16x16x32_bf16 v[144:147], a[48:51], a[8:11], v[144:147]
  ds_read_b64_tr_b16 a[66:67], v10 offset:13856
  v_mfma_f32_16x16x32_bf16 v[148:151], a[48:51], a[12:15], v[148:151]
  ds_read_b64_tr_b16 a[68:69], v10 offset:9280
  v_mfma_f32_16x16x32_bf16 v[152:155], a[48:51], a[16:19], v[152:155]
  ds_read_b64_tr_b16 a[70:71], v10 offset:13888
  v_mfma_f32_16x16x32_bf16 v[156:159], a[52:55], a[0:3], v[156:159]
  buffer_load_dwordx4 v4, s[8:11], s34 offen offset:1024  lds
  s_mov_b32 m0, s50
  v_mfma_f32_16x16x32_bf16 v[160:163], a[52:55], a[4:7], v[160:163]
  ds_read_b64_tr_b16 a[72:73], v10 offset:9312
  v_mfma_f32_16x16x32_bf16 v[164:167], a[52:55], a[8:11], v[164:167]
  ds_read_b64_tr_b16 a[74:75], v10 offset:13920
  v_mfma_f32_16x16x32_bf16 v[168:171], a[52:55], a[12:15], v[168:171]
  ds_read_b64_tr_b16 a[76:77], v39 offset:9216
  v_mfma_f32_16x16x32_bf16 v[172:175], a[52:55], a[16:19], v[172:175]
  buffer_load_dwordx4 v5, s[28:31], s35 offen sc1 lds
  v_mfma_f32_16x16x32_bf16 v[176:179], a[56:59], a[0:3], v[176:179]
  ds_read_b64_tr_b16 a[78:79], v39 offset:13824
  v_mfma_f32_16x16x32_bf16 v[180:183], a[56:59], a[4:7], v[180:183]
  v_mfma_f32_16x16x32_bf16 v[184:187], a[56:59], a[8:11], v[184:187]
  s_waitcnt vmcnt(8) lgkmcnt(0)
  s_barrier
  v_mfma_f32_16x16x32_bf16 v[96:99], a[60:63], a[20:23], v[96:99]
  s_mul_i32 s33, s32, 10240
  s_mul_i32 s34, s32, 36864
  v_mfma_f32_16x16x32_bf16 v[100:103], a[60:63], a[24:27], v[100:103]
  s_mul_i32 s35, s32, s41
  s_add_u32 m0, s42, 10240
  v_mfma_f32_16x16x32_bf16 v[104:107], a[60:63], a[28:31], v[104:107]
  s_add_u32 s32, s32, 1
  s_and_b32 s32, s32, 31
  v_mfma_f32_16x16x32_bf16 v[108:111], a[60:63], a[32:35], v[108:111]
  buffer_load_dwordx4 v2, s[4:7], s33 offen offset:0 sc1 lds
  ds_read_b128 a[0:3], v8 offset:20480
  v_mfma_f32_16x16x32_bf16 v[112:115], a[60:63], a[36:39], v[112:115]
  ds_read_b128 a[4:7], v8 offset:21504
  v_mfma_f32_16x16x32_bf16 v[116:119], a[64:67], a[20:23], v[116:119]
  ds_read_b128 a[8:11], v37 offset:22528
  v_mfma_f32_16x16x32_bf16 v[120:123], a[64:67], a[24:27], v[120:123]
  ds_read_b128 a[12:15], v37 offset:23552
  v_mfma_f32_16x16x32_bf16 v[124:127], a[64:67], a[28:31], v[124:127]
  buffer_load_dwordx4 v2, s[4:7], s33 offen offset:1024 sc1 lds
  s_add_u32 m0, s43, 9216
  v_mfma_f32_16x16x32_bf16 v[128:131], a[64:67], a[32:35], v[128:131]
  ds_read_b128 a[16:19], v37 offset:24576
  v_mfma_f32_16x16x32_bf16 v[132:135], a[64:67], a[36:39], v[132:135]
  ds_read_b64_tr_b16 a[40:41], v10 offset:18432
  v_mfma_f32_16x16x32_bf16 v[136:139], a[68:71], a[20:23], v[136:139]
  ds_read_b64_tr_b16 a[42:43], v10 offset:23040
  v_mfma_f32_16x16x32_bf16 v[140:143], a[68:71], a[24:27], v[140:143]
  buffer_load_dwordx4 v3, s[8:11], s34 offen offset:0  lds
  ds_read_b64_tr_b16 a[44:45], v10 offset:18464
  v_mfma_f32_16x16x32_bf16 v[144:147], a[68:71], a[28:31], v[144:147]
  ds_read_b64_tr_b16 a[46:47], v10 offset:23072
  v_mfma_f32_16x16x32_bf16 v[148:151], a[68:71], a[32:35], v[148:151]
  ds_read_b64_tr_b16 a[48:49], v10 offset:18496
  v_mfma_f32_16x16x32_bf16 v[152:155], a[68:71], a[36:39], v[152:155]
  ds_read_b64_tr_b16 a[50:51], v10 offset:23104
  v_mfma_f32_16x16x32_bf16 v[156:159], a[72:75], a[20:23], v[156:159]
  buffer_load_dwordx4 v4, s[8:11], s34 offen offset:1024  lds
  s_mov_b32 m0, s51
  v_mfma_f32_16x16x32_bf16 v[160:163], a[72:75], a[24:27], v[160:163]
  ds_read_b64_tr_b16 a[52:53], v10 offset:18528
  v_mfma_f32_16x16x32_bf16 v[164:167], a[72:75], a[28:31], v[164:167]
  ds_read_b64_tr_b16 a[54:55], v10 offset:23136
  v_mfma_f32_16x16x32_bf16 v[168:171], a[72:75], a[32:35], v[168:171]
  ds_read_b64_tr_b16 a[56:57], v39 offset:18432
  v_mfma_f32_16x16x32_bf16 v[172:175], a[72:75], a[36:39], v[172:175]
  buffer_load_dwordx4 v5, s[28:31], s35 offen sc1 lds
  v_mfma_f32_16x16x32_bf16 v[176:179], a[76:79], a[20:23], v[176:179]
  ds_read_b64_tr_b16 a[58:59], v39 offset:23040
  v_mfma_f32_16x16x32_bf16 v[180:183], a[76:79], a[24:27], v[180:183]
  v_mfma_f32_16x16x32_bf16 v[184:187], a[76:79], a[28:31], v[184:187]
  s_waitcnt vmcnt(10) lgkmcnt(0)
  s_barrier
  v_mfma_f32_16x16x32_bf16 v[96:99], a[40:43], a[0:3], v[96:99]
  s_mul_i32 s33, s32, 10240
  s_mul_i32 s34, s32, 36864
  v_mfma_f32_16x16x32_bf16 v[100:103], a[40:43], a[4:7], v[100:103]
  s_mul_i32 s35, s32, s41
  s_add_u32 m0, s42, 20480
  v_mfma_f32_16x16x32_bf16 v[104:107], a[40:43], a[8:11], v[104:107]
  s_add_u32 s32, s32, 1
  s_and_b32 s32, s32, 31
  v_mfma_f32_16x16x32_bf16 v[108:111], a[40:43], a[12:15], v[108:111]
  buffer_load_dwordx4 v2, s[4:7], s33 offen offset:0 sc1 lds
  ds_read_b128 a[20:23], v8 offset:30720
  v_mfma_f32_16x16x32_bf16 v[112:115], a[40:43], a[16:19], v[112:115]
  ds_read_b128 a[24:27], v8 offset:31744
  v_mfma_f32_16x16x32_bf16 v[116:119], a[44:47], a[0:3], v[116:119]
  ds_read_b128 a[28:31], v37 offset:32768
  v_mfma_f32_16x16x32_bf16 v[120:123], a[44:47], a[4:7], v[120:123]
  ds_read_b128 a[32:35], v37 offset:33792
  v_mfma_f32_16x16x32_bf16 v[124:127], a[44:47], a[8:11], v[124:127]
  buffer_load_dwordx4 v2, s[4:7], s33 offen offset:1024 sc1 lds
  s_add_u32 m0, s43, 18432
  v_mfma_f32_16x16x32_bf16 v[128:131], a[44:47], a[12:15], v[128:131]
  ds_read_b128 a[36:39], v37 offset:34816
  v_mfma_f32_16x16x32_bf16 v[132:135], a[44:47], a[16:19], v[132:135]
  ds_read_b64_tr_b16 a[60:61], v10 offset:27648
  v_mfma_f32_16x16x32_bf16 v[136:139], a[48:51], a[0:3], v[136:139]
  ds_read_b64_tr_b16 a[62:63], v10 offset:32256
  v_mfma_f32_16x16x32_bf16 v[140:143], a[48:51], a[4:7], v[140:143]
  buffer_load_dwordx4 v3, s[8:11], s34 offen offset:0  lds
  ds_read_b64_tr_b16 a[64:65], v10 offset:27680
  v_mfma_f32_16x16x32_bf16 v[144:147], a[48:51], a[8:11], v[144:147]
  ds_read_b64_tr_b16 a[66:67], v10 offset:32288
  v_mfma_f32_16x16x32_bf16 v[148:151], a[48:51], a[12:15], v[148:151]
  ds_read_b64_tr_b16 a[68:69], v10 offset:27712
  v_mfma_f32_16x16x32_bf16 v[152:155], a[48:51], a[16:19], v[152:155]
  ds_read_b64_tr_b16 a[70:71], v10 offset:32320
  v_mfma_f32_16x16x32_bf16 v[156:159], a[52:55], a[0:3], v[156:159]
  buffer_load_dwordx4 v4, s[8:11], s34 offen offset:1024  lds
  s_mov_b32 m0, s52
  v_mfma_f32_16x16x32_bf16 v[160:163], a[52:55], a[4:7], v[160:163]
  ds_read_b64_tr_b16 a[72:73], v10 offset:27744
  v_mfma_f32_16x16x32_bf16 v[164:167], a[52:55], a[8:11], v[164:167]
  ds_read_b64_tr_b16 a[74:75], v10 offset:32352
  v_mfma_f32_16x16x32_bf16 v[168:171], a[52:55], a[12:15], v[168:171]
  ds_read_b64_tr_b16 a[76:77], v39 offset:27648
  v_mfma_f32_16x16x32_bf16 v[172:175], a[52:55], a[16:19], v[172:175]
  buffer_load_dwordx4 v5, s[28:31], s35 offen sc1 lds
  v_mfma_f32_16x16x32_bf16 v[176:179], a[56:59], a[0:3], v[176:179]
  ds_read_b64_tr_b16 a[78:79], v39 offset:32256
  v_mfma_f32_16x16x32_bf16 v[180:183], a[56:59], a[4:7], v[180:183]
  v_mfma_f32_16x16x32_bf16 v[184:187], a[56:59], a[8:11], v[184:187]
  s_waitcnt vmcnt(10) lgkmcnt(0)
  s_barrier
  v_mfma_f32_16x16x32_bf16 v[96:99], a[60:63], a[20:23], v[96:99]
  s_mul_i32 s33, s32, 10240
  s_mul_i32 s34, s32, 36864
  v_mfma_f32_16x16x32_bf16 v[100:103], a[60:63], a[24:27], v[100:103]
  s_mul_i32 s35, s32, s41
  s_add_u32 m0, s42, 30720
  v_mfma_f32_16x16x32_bf16 v[104:107], a[60:63], a[28:31], v[104:107]
  s_add_u32 s32, s32, 1
  s_and_b32 s32, s32, 31
  v_mfma_f32_16x16x32_bf16 v[108:111], a[60:63], a[32:35], v[108:111]
  buffer_load_dwordx4 v2, s[4:7], s33 offen offset:0 sc1 lds
  ds_read_b128 a[0:3], v9 offset:0
  v_mfma_f32_16x16x32_bf16 v[112:115], a[60:63], a[36:39], v[112:115]
  ds_read_b128 a[4:7], v9 offset:1024
  v_mfma_f32_16x16x32_bf16 v[116:119], a[64:67], a[20:23], v[116:119]
  ds_read_b128 a[8:11], v38 offset:2048
  v_mfma_f32_16x16x32_bf16 v[120:123], a[64:67], a[24:27], v[120:123]
  ds_read_b128 a[12:15], v38 offset:3072
  v_mfma_f32_16x16x32_bf16 v[124:127], a[64:67], a[28:31], v[124:127]
  buffer_load_dwordx4 v2, s[4:7], s33 offen offset:1024 sc1 lds
  s_add_u32 m0, s43, 27648
  v_mfma_f32_16x16x32_bf16 v[128:131], a[64:67], a[32:35], v[128:131]
  ds_read_b128 a[16:19], v38 offset:4096
  v_mfma_f32_16x16x32_bf16 v[132:135], a[64:67], a[36:39], v[132:135]
  ds_read_b64_tr_b16 a[40:41], v10 offset:0
  v_mfma_f32_16x16x32_bf16 v[136:139], a[68:71], a[20:23], v[136:139]
  ds_read_b64_tr_b16 a[42:43], v10 offset:4608
  v_mfma_f32_16x16x32_bf16 v[140:143], a[68:71], a[24:27], v[140:143]
  buffer_load_dwordx4 v3, s[8:11], s34 offen offset:0  lds
  ds_read_b64_tr_b16 a[44:45], v10 offset:32
  v_mfma_f32_16x16x32_bf16 v[144:147], a[68:71], a[28:31], v[144:147]
  ds_read_b64_tr_b16 a[46:47], v10 offset:4640
  v_mfma_f32_16x16x32_bf16 v[148:151], a[68:71], a[32:35], v[148:151]
  ds_read_b64_tr_b16 a[48:49], v10 offset:64
  v_mfma_f32_16x16x32_bf16 v[152:155], a[68:71], a[36:39], v[152:155]
  ds_read_b64_tr_b16 a[50:51], v10 offset:4672
  v_mfma_f32_16x16x32_bf16 v[156:159], a[72:75], a[20:23], v[156:159]
  buffer_load_dwordx4 v4, s[8:11], s34 offen offset:1024  lds
  s_mov_b32 m0, s53
  v_mfma_f32_16x16x32_bf16 v[160:163], a[72:75], a[24:27], v[160:163]
  ds_read_b64_tr_b16 a[52:53], v10 offset:96
  v_mfma_f32_16x16x32_bf16 v[164:167], a[72:75], a[28:31], v[164:167]
  ds_read_b64_tr_b16 a[54:55], v10 offset:4704
  v_mfma_f32_16x16x32_bf16 v[168:171], a[72:75], a[32:35], v[168:171]
  ds_read_b64_tr_b16 a[56:57], v39 offset:0
  v_mfma_f32_16x16x32_bf16 v[172:175], a[72:75], a[36:39], v[172:175]
  buffer_load_dwordx4 v5, s[28:31], s35 offen sc1 lds
  v_mfma_f32_16x16x32_bf16 v[176:179], a[76:79], a[20:23], v[176:179]
  ds_read_b64_tr_b16 a[58:59], v39 offset:4608
  v_mfma_f32_16x16x32_bf16 v[180:183], a[76:79], a[24:27], v[180:183]
  v_mfma_f32_16x16x32_bf16 v[184:187], a[76:79], a[28:31], v[184:187]
  s_waitcnt vmcnt(10) lgkmcnt(0)
  s_barrier
  s_mov_b32 s36, 0
.p2align 4
O2_loop:
  v_mfma_f32_16x16x32_bf16 v[96:99], a[40:43], a[0:3], v[96:99]
  s_mul_i32 s33, s32, 10240
  s_mul_i32 s34, s32, 36864
  v_mfma_f32_16x16x32_bf16 v[100:103], a[40:43], a[4:7], v[100:103]
  s_mul_i32 s35, s32, s41
  s_add_u32 m0, s42, 0
  v_mfma_f32_16x16x32_bf16 v[104:107], a[40:43], a[8:11], v[104:107]
  s_add_u32 s32, s32, 1
  s_and_b32 s32, s32, 31
  v_mfma_f32_16x16x32_bf16 v[108:111], a[40:43], a[12:15], v[108:111]
  buffer_load_dwordx4 v2, s[4:7], s33 offen offset:0 sc1 lds
  ds_read_b128 a[20:23], v9 offset:10240
  v_mfma_f32_16x16x32_bf16 v[112:115], a[40:43], a[16:19], v[112:115]
  ds_read_b128 a[24:27], v9 offset:11264
  v_mfma_f32_16x16x32_bf16 v[116:119], a[44:47], a[0:3], v[116:119]
  ds_read_b128 a[28:31], v38 offset:12288
  v_mfma_f32_16x16x32_bf16 v[120:123], a[44:47], a[4:7], v[120:123]
  ds_read_b128 a[32:35], v38 offset:13312
  v_mfma_f32_16x16x32_bf16 v[124:127], a[44:47], a[8:11], v[124:127]
  buffer_load_dwordx4 v2, s[4:7], s33 offen offset:1024 sc1 lds
  s_add_u32 m0, s43, 0
  v_mfma_f32_16x16x32_bf16 v[128:131], a[44:47], a[12:15], v[128:131]
  ds_read_b128 a[36:39], v38 offset:14336
  v_mfma_f32_16x16x32_bf16 v[132:135], a[44:47], a[16:19], v[132:135]
  ds_read_b64_tr_b16 a[60:61], v10 offset:9216
  v_mfma_f32_16x16x32_bf16 v[136:139], a[48:51], a[0:3], v[136:139]
  ds_read_b64_tr_b16 a[62:63], v10 offset:13824
  v_mfma_f32_16x16x32_bf16 v[140:143], a[48:51], a[4:7], v[140:143]
  buffer_load_dwordx4 v3, s[8:11], s34 offen offset:0  lds
  ds_read_b64_tr_b16 a[64:65], v10 offset:9248
  v_mfma_f32_16x16x32_bf16 v[144:147], a[48:51], a[8:11], v[144:147]
  ds_read_b64_tr_b16 a[66:67], v10 offset:13856
  v_mfma_f32_16x16x32_bf16 v[148:151], a[48:51], a[12:15], v[148:151]
  ds_read_b64_tr_b16 a[68:69], v10 offset:9280
  v_mfma_f32_16x16x32_bf16 v[152:155], a[48:51], a[16:19], v[152:155]
  ds_read_b64_tr_b16 a[70:71], v10 offset:13888
  v_mfma_f32_16x16x32_bf16 v[156:159], a[52:55], a[0:3], v[156:159]
  buffer_load_dwordx4 v4, s[8:11], s34 offen offset:1024  lds
  s_mov_b32 m0, s50
  v_mfma_f32_16x16x32_bf16 v[160:163], a[52:55], a[4:7], v[160:163]
  ds_read_b64_tr_b16 a[72:73], v10 offset:9312
  v_mfma_f32_16x16x32_bf16 v[164:167], a[52:55], a[8:11], v[164:167]
  ds_read_b64_tr_b16 a[74:75], v10 offset:13920
  v_mfma_f32_16x16x32_bf16 v[168:171], a[52:55], a[12:15], v[168:171]
  ds_read_b64_tr_b16 a[76:77], v39 offset:9216
  v_mfma_f32_16x16x32_bf16 v[172:175], a[52:55], a[16:19], v[172:175]
  buffer_load_dwordx4 v5, s[28:31], s35 offen sc1 lds
  v_mfma_f32_16x16x32_bf16 v[176:179], a[56:59], a[0:3], v[176:179]
  ds_read_b64_tr_b16 a[78:79], v39 offset:13824
  v_mfma_f32_16x16x32_bf16 v[180:183], a[56:59], a[4:7], v[180:183]
  v_mfma_f32_16x16x32_bf16 v[184:187], a[56:59], a[8:11], v[184:187]
  s_waitcnt vmcnt(10) lgkmcnt(0)
  s_barrier
  v_mfma_f32_16x16x32_bf16 v[96:99], a[60:63], a[20:23], v[96:99]
  s_mul_i32 s33, s32, 10240
  s_mul_i32 s34, s32, 36864
  v_mfma_f32_16x16x32_bf16 v[100:103], a[60:63], a[24:27], v[100:103]
  s_mul_i32 s35, s32, s41
  s_add_u32 m0, s42, 10240
  v_mfma_f32_16x16x32_bf16 v[104:107], a[60:63], a[28:31], v[104:107]
  s_add_u32 s32, s32, 1
  s_and_b32 s32, s32, 31
  v_mfma_f32_16x16x32_bf16 v[108:111], a[60:63], a[32:35], v[108:111]
  buffer_load_dwordx4 v2, s[4:7], s33 offen offset:0 sc1 lds
  ds_read_b128 a[0:3], v9 offset:20480
  v_mfma_f32_16x16x32_bf16 v[112:115], a[60:63], a[36:39], v[112:115]
  ds_read_b128 a[4:7], v9 offset:21504
  v_mfma_f32_16x16x32_bf16 v[116:119], a[64:67], a[20:23], v[116:119]
  ds_read_b128 a[8:11], v38 offset:22528
  v_mfma_f32_16x16x32_bf16 v[120:123], a[64:67], a[24:27], v[120:123]
  ds_read_b128 a[12:15], v38 offset:23552
  v_mfma_f32_16x16x32_bf16 v[124:127], a[64:67], a[28:31], v[124:127]
  buffer_load_dwordx4 v2, s[4:7], s33 offen offset:1024 sc1 lds
  s_add_u32 m0, s43, 9216
  v_mfma_f32_16x16x32_bf16 v[128:131], a[64:67], a[32:35], v[128:131]
  ds_read_b128 a[16:19], v38 offset:24576
  v_mfma_f32_16x16x32_bf16 v[132:135], a[64:67], a[36:39], v[132:135]
  ds_read_b64_tr_b16 a[40:41], v10 offset:18432
  v_mfma_f32_16x16x32_bf16 v[136:139], a[68:71], a[20:23], v[136:139]
  ds_read_b64_tr_b16 a[42:43], v10 offset:23040
  v_mfma_f32_16x16x32_bf16 v[140:143], a[68:71], a[24:27], v[140:143]
  buffer_load_dwordx4 v3, s[8:11], s34 offen offset:0  lds
  ds_read_b64_tr_b16 a[44:45], v10 offset:18464
  v_mfma_f32_16x16x32_bf16 v[144:147], a[68:71], a[28:31], v[144:147]
  ds_read_b64_tr_b16 a[46:47], v10 offset:23072
  v_mfma_f32_16x16x32_bf16 v[148:151], a[68:71], a[32:35], v[148:151]
  ds_read_b64_tr_b16 a[48:49], v10 offset:18496
  v_mfma_f32_16x16x32_bf16 v[152:155], a[68:71], a[36:39], v[152:155]
  ds_read_b64_tr_b16 a[50:51], v10 offset:23104
  v_mfma_f32_16x16x32_bf16 v[156:159], a[72:75], a[20:23], v[156:159]
  buffer_load_dwordx4 v4, s[8:11], s34 offen offset:1024  lds
  s_mov_b32 m0, s51
  v_mfma_f32_16x16x32_bf16 v[160:163], a[72:75], a[24:27], v[160:163]
  ds_read_b64_tr_b16 a[52:53], v10 offset:18528
  v_mfma_f32_16x16x32_bf16 v[164:167], a[72:75], a[28:31], v[164:167]
  ds_read_b64_tr_b16 a[54:55], v10 offset:23136
  v_mfma_f32_16x16x32_bf16 v[168:171], a[72:75], a[32:35], v[168:171]
  ds_read_b64_tr_b16 a[56:57], v39 offset:18432
  v_mfma_f32_16x16x32_bf16 v[172:175], a[72:75], a[36:39], v[172:175]
  buffer_load_dwordx4 v5, s[28:31], s35 offen sc1 lds
  v_mfma_f32_16x16x32_bf16 v[176:179], a[76:79], a[20:23], v[176:179]
  ds_read_b64_tr_b16 a[58:59], v39 offset:23040
  v_mfma_f32_16x16x32_bf16 v[180:183], a[76:79], a[24:27], v[180:183]
  v_mfma_f32_16x16x32_bf16 v[184:187], a[76:79], a[28:31], v[184:187]
  s_waitcnt vmcnt(10) lgkmcnt(0)
  s_barrier
  v_mfma_f32_16x16x32_bf16 v[96:99], a[40:43], a[0:3], v[96:99]
  s_mul_i32 s33, s32, 10240
  s_mul_i32 s34, s32, 36864
  v_mfma_f32_16x16x32_bf16 v[100:103], a[40:43], a[4:7], v[100:103]
  s_mul_i32 s35, s32, s41
  s_add_u32 m0, s42, 20480
  v_mfma_f32_16x16x32_bf16 v[104:107], a[40:43], a[8:11], v[104:107]
  s_add_u32 s32, s32, 1
  s_and_b32 s32, s32, 31
  v_mfma_f32_16x16x32_bf16 v[108:111], a[40:43], a[12:15], v[108:111]
  buffer_load_dwordx4 v2, s[4:7], s33 offen offset:0 sc1 lds
  ds_read_b128 a[20:23], v9 offset:30720
  v_mfma_f32_16x16x32_bf16 v[112:115], a[40:43], a[16:19], v[112:115]
  ds_read_b128 a[24:27], v9 offset:31744
  v_mfma_f32_16x16x32_bf16 v[116:119], a[44:47], a[0:3], v[116:119]
  ds_read_b128 a[28:31], v38 offset:32768
  v_mfma_f32_16x16x32_bf16 v[120:123], a[44:47], a[4:7], v[120:123]
  ds_read_b128 a[32:35], v38 offset:33792
  v_mfma_f32_16x16x32_bf16 v[124:127], a[44:47], a[8:11], v[124:127]
  buffer_load_dwordx4 v2, s[4:7], s33 offen offset:1024 sc1 lds
  s_add_u32 m0, s43, 18432
  v_mfma_f32_16x16x32_bf16 v[128:131], a[44:47], a[12:15], v[128:131]
  ds_read_b128 a[36:39], v38 offset:34816
  v_mfma_f32_16x16x32_bf16 v[132:135], a[44:47], a[16:19], v[132:135]
  ds_read_b64_tr_b16 a[60:61], v10 offset:27648
  v_mfma_f32_16x16x32_bf16 v[136:139], a[48:51], a[0:3], v[136:139]
  ds_read_b64_tr_b16 a[62:63], v10 offset:32256
  v_mfma_f32_16x16x32_bf16 v[140:143], a[48:51], a[4:7], v[140:143]
  buffer_load_dwordx4 v3, s[8:11], s34 offen offset:0  lds
  ds_read_b64_tr_b16 a[64:65], v10 offset:27680
  v_mfma_f32_16x16x32_bf16 v[144:147], a[48:51], a[8:11], v[144:147]
  ds_read_b64_tr_b16 a[66:67], v10 offset:32288
  v_mfma_f32_16x16x32_bf16 v[148:151], a[48:51], a[12:15], v[148:151]
  ds_read_b64_tr_b16 a[68:69], v10 offset:27712
  v_mfma_f32_16x16x32_bf16 v[152:155], a[48:51], a[16:19], v[152:155]
  ds_read_b64_tr_b16 a[70:71], v10 offset:32320
  v_mfma_f32_16x16x32_bf16 v[156:159], a[52:55], a[0:3], v[156:159]
  buffer_load_dwordx4 v4, s[8:11], s34 offen offset:1024  lds
  s_mov_b32 m0, s52
  v_mfma_f32_16x16x32_bf16 v[160:163], a[52:55], a[4:7], v[160:163]
  ds_read_b64_tr_b16 a[72:73], v10 offset:27744
  v_mfma_f32_16x16x32_bf16 v[164:167], a[52:55], a[8:11], v[164:167]
  ds_read_b64_tr_b16 a[74:75], v10 offset:32352
  v_mfma_f32_16x16x32_bf16 v[168:171], a[52:55], a[12:15], v[168:171]
  ds_read_b64_tr_b16 a[76:77], v39 offset:27648
  v_mfma_f32_16x16x32_bf16 v[172:175], a[52:55], a[16:19], v[172:175]
  buffer_load_dwordx4 v5, s[28:31], s35 offen sc1 lds
  v_mfma_f32_16x16x32_bf16 v[176:179], a[56:59], a[0:3], v[176:179]
  ds_read_b64_tr_b16 a[78:79], v39 offset:32256
  v_mfma_f32_16x16x32_bf16 v[180:183], a[56:59], a[4:7], v[180:183]
  v_mfma_f32_16x16x32_bf16 v[184:187], a[56:59], a[8:11], v[184:187]
  s_waitcnt vmcnt(10) lgkmcnt(0)
  s_barrier
  v_mfma_f32_16x16x32_bf16 v[96:99], a[60:63], a[20:23], v[96:99]
  s_mul_i32 s33, s32, 10240
  s_mul_i32 s34, s32, 36864
  v_mfma_f32_16x16x32_bf16 v[100:103], a[60:63], a[24:27], v[100:103]
  s_mul_i32 s35, s32, s41
  s_add_u32 m0, s42, 30720
  v_mfma_f32_16x16x32_bf16 v[104:107], a[60:63], a[28:31], v[104:107]
  s_add_u32 s32, s32, 1
  s_and_b32 s32, s32, 31
  v_mfma_f32_16x16x32_bf16 v[108:111], a[60:63], a[32:35], v[108:111]
  buffer_load_dwordx4 v2, s[4:7], s33 offen offset:0 sc1 lds
  ds_read_b128 a[0:3], v9 offset:0
  v_mfma_f32_16x16x32_bf16 v[112:115], a[60:63], a[36:39], v[112:115]
  ds_read_b128 a[4:7], v9 offset:1024
  v_mfma_f32_16x16x32_bf16 v[116:119], a[64:67], a[20:23], v[116:119]
  ds_read_b128 a[8:11], v38 offset:2048
  v_mfma_f32_16x16x32_bf16 v[120:123], a[64:67], a[24:27], v[120:123]
  ds_read_b128 a[12:15], v38 offset:3072
  v_mfma_f32_16x16x32_bf16 v[124:127], a[64:67], a[28:31], v[124:127]
  buffer_load_dwordx4 v2, s[4:7], s33 offen offset:1024 sc1 lds
  s_add_u32 m0, s43, 27648
  v_mfma_f32_16x16x32_bf16 v[128:131], a[64:67], a[32:35], v[128:131]
  ds_read_b128 a[16:19], v38 offset:4096
  v_mfma_f32_16x16x32_bf16 v[132:135], a[64:67], a[36:39], v[132:135]
  ds_read_b64_tr_b16 a[40:41], v10 offset:0
  v_mfma_f32_16x16x32_bf16 v[136:139], a[68:71], a[20:23], v[136:139]
  ds_read_b64_tr_b16 a[42:43], v10 offset:4608
  v_mfma_f32_16x16x32_bf16 v[140:143], a[68:71], a[24:27], v[140:143]
  buffer_load_dwordx4 v3, s[8:11], s34 offen offset:0  lds
  ds_read_b64_tr_b16 a[44:45], v10 offset:32
  v_mfma_f32_16x16x32_bf16 v[144:147], a[68:71], a[28:31], v[144:147]
  ds_read_b64_tr_b16 a[46:47], v10 offset:4640
  v_mfma_f32_16x16x32_bf16 v[148:151], a[68:71], a[32:35], v[148:151]
  ds_read_b64_tr_b16 a[48:49], v10 offset:64
  v_mfma_f32_16x16x32_bf16 v[152:155], a[68:71], a[36:39], v[152:155]
  ds_read_b64_tr_b16 a[50:51], v10 offset:4672
  v_mfma_f32_16x16x32_bf16 v[156:159], a[72:75], a[20:23], v[156:159]
  buffer_load_dwordx4 v4, s[8:11], s34 offen offset:1024  lds
  s_mov_b32 m0, s53
  v_mfma_f32_16x16x32_bf16 v[160:163], a[72:75], a[24:27], v[160:163]
  ds_read_b64_tr_b16 a[52:53], v10 offset:96
  v_mfma_f32_16x16x32_bf16 v[164:167], a[72:75], a[28:31], v[164:167]
  ds_read_b64_tr_b16 a[54:55], v10 offset:4704
  v_mfma_f32_16x16x32_bf16 v[168:171], a[72:75], a[32:35], v[168:171]
  ds_read_b64_tr_b16 a[56:57], v39 offset:0
  v_mfma_f32_16x16x32_bf16 v[172:175], a[72:75], a[36:39], v[172:175]
  buffer_load_dwordx4 v5, s[28:31], s35 offen sc1 lds
  v_mfma_f32_16x16x32_bf16 v[176:179], a[76:79], a[20:23], v[176:179]
  ds_read_b64_tr_b16 a[58:59], v39 offset:4608
  v_mfma_f32_16x16x32_bf16 v[180:183], a[76:79], a[24:27], v[180:183]
  v_mfma_f32_16x16x32_bf16 v[184:187], a[76:79], a[28:31], v[184:187]
  s_waitcnt vmcnt(10) lgkmcnt(0)
  s_add_u32 s36, s36, 1
  s_cmp_lt_u32 s36, 5
  s_barrier
  s_cbranch_scc1 O2_loop
  v_mfma_f32_16x16x32_bf16 v[96:99], a[40:43], a[0:3], v[96:99]
  v_mfma_f32_16x16x32_bf16 v[100:103], a[40:43], a[4:7], v[100:103]
  v_mfma_f32_16x16x32_bf16 v[104:107], a[40:43], a[8:11], v[104:107]
  ds_read_b128 a[20:23], v9 offset:10240
  v_mfma_f32_16x16x32_bf16 v[108:111], a[40:43], a[12:15], v[108:111]
  ds_read_b128 a[24:27], v9 offset:11264
  v_mfma_f32_16x16x32_bf16 v[112:115], a[40:43], a[16:19], v[112:115]
  ds_read_b128 a[28:31], v38 offset:12288
  v_mfma_f32_16x16x32_bf16 v[116:119], a[44:47], a[0:3], v[116:119]
  ds_read_b128 a[32:35], v38 offset:13312
  v_mfma_f32_16x16x32_bf16 v[120:123], a[44:47], a[4:7], v[120:123]
  ds_read_b128 a[36:39], v38 offset:14336
  v_mfma_f32_16x16x32_bf16 v[124:127], a[44:47], a[8:11], v[124:127]
  ds_read_b64_tr_b16 a[60:61], v10 offset:9216
  v_mfma_f32_16x16x32_bf16 v[128:131], a[44:47], a[12:15], v[128:131]
  ds_read_b64_tr_b16 a[62:63], v10 offset:13824
  v_mfma_f32_16x16x32_bf16 v[132:135], a[44:47], a[16:19], v[132:135]
  ds_read_b64_tr_b16 a[64:65], v10 offset:9248
  v_mfma_f32_16x16x32_bf16 v[136:139], a[48:51], a[0:3], v[136:139]
  ds_read_b64_tr_b16 a[66:67], v10 offset:13856
  v_mfma_f32_16x16x32_bf16 v[140:143], a[48:51], a[4:7], v[140:143]
  ds_read_b64_tr_b16 a[68:69], v10 offset:9280
  v_mfma_f32_16x16x32_bf16 v[144:147], a[48:51], a[8:11], v[144:147]
  ds_read_b64_tr_b16 a[70:71], v10 offset:13888
  v_mfma_f32_16x16x32_bf16 v[148:151], a[48:51], a[12:15], v[148:151]
  ds_read_b64_tr_b16 a[72:73], v10 offset:9312
  v_mfma_f32_16x16x32_bf16 v[152:155], a[48:51], a[16:19], v[152:155]
  ds_read_b64_tr_b16 a[74:75], v10 offset:13920
  v_mfma_f32_16x16x32_bf16 v[156:159], a[52:55], a[0:3], v[156:159]
  ds_read_b64_tr_b16 a[76:77], v39 offset:9216
  v_mfma_f32_16x16x32_bf16 v[160:163], a[52:55], a[4:7], v[160:163]
  ds_read_b64_tr_b16 a[78:79], v39 offset:13824
  v_mfma_f32_16x16x32_bf16 v[164:167], a[52:55], a[8:11], v[164:167]
  v_mfma_f32_16x16x32_bf16 v[168:171], a[52:55], a[12:15], v[168:171]
  v_mfma_f32_16x16x32_bf16 v[172:175], a[52:55], a[16:19], v[172:175]
  v_mfma_f32_16x16x32_bf16 v[176:179], a[56:59], a[0:3], v[176:179]
  v_mfma_f32_16x16x32_bf16 v[180:183], a[56:59], a[4:7], v[180:183]
  v_mfma_f32_16x16x32_bf16 v[184:187], a[56:59], a[8:11], v[184:187]
  s_waitcnt vmcnt(5) lgkmcnt(0)
  s_barrier
  v_mfma_f32_16x16x32_bf16 v[96:99], a[60:63], a[20:23], v[96:99]
  v_mfma_f32_16x16x32_bf16 v[100:103], a[60:63], a[24:27], v[100:103]
  v_mfma_f32_16x16x32_bf16 v[104:107], a[60:63], a[28:31], v[104:107]
  ds_read_b128 a[0:3], v9 offset:20480
  v_mfma_f32_16x16x32_bf16 v[108:111], a[60:63], a[32:35], v[108:111]
  ds_read_b128 a[4:7], v9 offset:21504
  v_mfma_f32_16x16x32_bf16 v[112:115], a[60:63], a[36:39], v[112:115]
  ds_read_b128 a[8:11], v38 offset:22528
  v_mfma_f32_16x16x32_bf16 v[116:119], a[64:67], a[20:23], v[116:119]
  ds_read_b128 a[12:15], v38 offset:23552
  v_mfma_f32_16x16x32_bf16 v[120:123], a[64:67], a[24:27], v[120:123]
  ds_read_b128 a[16:19], v38 offset:24576
  v_mfma_f32_16x16x32_bf16 v[124:127], a[64:67], a[28:31], v[124:127]
  ds_read_b64_tr_b16 a[40:41], v10 offset:18432
  v_mfma_f32_16x16x32_bf16 v[128:131], a[64:67], a[32:35], v[128:131]
  ds_read_b64_tr_b16 a[42:43], v10 offset:23040
  v_mfma_f32_16x16x32_bf16 v[132:135], a[64:67], a[36:39], v[132:135]
  ds_read_b64_tr_b16 a[44:45], v10 offset:18464
  v_mfma_f32_16x16x32_bf16 v[136:139], a[68:71], a[20:23], v[136:139]
  ds_read_b64_tr_b16 a[46:47], v10 offset:23072
  v_mfma_f32_16x16x32_bf16 v[140:143], a[68:71], a[24:27], v[140:143]
  ds_read_b64_tr_b16 a[48:49], v10 offset:18496
  v_mfma_f32_16x16x32_bf16 v[144:147], a[68:71], a[28:31], v[144:147]
  ds_read_b64_tr_b16 a[50:51], v10 offset:23104
  v_mfma_f32_16x16x32_bf16 v[148:151], a[68:71], a[32:35], v[148:151]
  ds_read_b64_tr_b16 a[52:53], v10 offset:18528
  v_mfma_f32_16x16x32_bf16 v[152:155], a[68:71], a[36:39], v[152:155]
  ds_read_b64_tr_b16 a[54:55], v10 offset:23136
  v_mfma_f32_16x16x32_bf16 v[156:159], a[72:75], a[20:23], v[156:159]
  ds_read_b64_tr_b16 a[56:57], v39 offset:18432
  v_mfma_f32_16x16x32_bf16 v[160:163], a[72:75], a[24:27], v[160:163]
  ds_read_b64_tr_b16 a[58:59], v39 offset:23040
  v_mfma_f32_16x16x32_bf16 v[164:167], a[72:75], a[28:31], v[164:167]
  v_mfma_f32_16x16x32_bf16 v[168:171], a[72:75], a[32:35], v[168:171]
  v_mfma_f32_16x16x32_bf16 v[172:175], a[72:75], a[36:39], v[172:175]
  v_mfma_f32_16x16x32_bf16 v[176:179], a[76:79], a[20:23], v[176:179]
  v_mfma_f32_16x16x32_bf16 v[180:183], a[76:79], a[24:27], v[180:183]
  v_mfma_f32_16x16x32_bf16 v[184:187], a[76:79], a[28:31], v[184:187]
  s_waitcnt vmcnt(0) lgkmcnt(0)
  s_barrier
  v_mfma_f32_16x16x32_bf16 v[96:99], a[40:43], a[0:3], v[96:99]
  v_mfma_f32_16x16x32_bf16 v[100:103], a[40:43], a[4:7], v[100:103]
  v_mfma_f32_16x16x32_bf16 v[104:107], a[40:43], a[8:11], v[104:107]
  ds_read_b128 a[20:23], v9 offset:30720
  v_mfma_f32_16x16x32_bf16 v[108:111], a[40:43], a[12:15], v[108:111]
  ds_read_b128 a[24:27], v9 offset:31744
  v_mfma_f32_16x16x32_bf16 v[112:115], a[40:43], a[16:19], v[112:115]
  ds_read_b128 a[28:31], v38 offset:32768
  v_mfma_f32_16x16x32_bf16 v[116:119], a[44:47], a[0:3], v[116:119]
  ds_read_b128 a[32:35], v38 offset:33792
  v_mfma_f32_16x16x32_bf16 v[120:123], a[44:47], a[4:7], v[120:123]
  ds_read_b128 a[36:39], v38 offset:34816
  v_mfma_f32_16x16x32_bf16 v[124:127], a[44:47], a[8:11], v[124:127]
  ds_read_b64_tr_b16 a[60:61], v10 offset:27648
  v_mfma_f32_16x16x32_bf16 v[128:131], a[44:47], a[12:15], v[128:131]
  ds_read_b64_tr_b16 a[62:63], v10 offset:32256
  v_mfma_f32_16x16x32_bf16 v[132:135], a[44:47], a[16:19], v[132:135]
  ds_read_b64_tr_b16 a[64:65], v10 offset:27680
  v_mfma_f32_16x16x32_bf16 v[136:139], a[48:51], a[0:3], v[136:139]
  ds_read_b64_tr_b16 a[66:67], v10 offset:32288
  v_mfma_f32_16x16x32_bf16 v[140:143], a[48:51], a[4:7], v[140:143]
  ds_read_b64_tr_b16 a[68:69], v10 offset:27712
  v_mfma_f32_16x16x32_bf16 v[144:147], a[48:51], a[8:11], v[144:147]
  ds_read_b64_tr_b16 a[70:71], v10 offset:32320
  v_mfma_f32_16x16x32_bf16 v[148:151], a[48:51], a[12:15], v[148:151]
  ds_read_b64_tr_b16 a[72:73], v10 offset:27744
  v_mfma_f32_16x16x32_bf16 v[152:155], a[48:51], a[16:19], v[152:155]
  ds_read_b64_tr_b16 a[74:75], v10 offset:32352
  v_mfma_f32_16x16x32_bf16 v[156:159], a[52:55], a[0:3], v[156:159]
  ds_read_b64_tr_b16 a[76:77], v39 offset:27648
  v_mfma_f32_16x16x32_bf16 v[160:163], a[52:55], a[4:7], v[160:163]
  ds_read_b64_tr_b16 a[78:79], v39 offset:32256
  v_mfma_f32_16x16x32_bf16 v[164:167], a[52:55], a[8:11], v[164:167]
  v_mfma_f32_16x16x32_bf16 v[168:171], a[52:55], a[12:15], v[168:171]
  v_mfma_f32_16x16x32_bf16 v[172:175], a[52:55], a[16:19], v[172:175]
  v_mfma_f32_16x16x32_bf16 v[176:179], a[56:59], a[0:3], v[176:179]
  v_mfma_f32_16x16x32_bf16 v[180:183], a[56:59], a[4:7], v[180:183]
  v_mfma_f32_16x16x32_bf16 v[184:187], a[56:59], a[8:11], v[184:187]
  s_waitcnt lgkmcnt(0)
  v_mfma_f32_16x16x32_bf16 v[96:99], a[60:63], a[20:23], v[96:99]
  v_mfma_f32_16x16x32_bf16 v[100:103], a[60:63], a[24:27], v[100:103]
  v_mfma_f32_16x16x32_bf16 v[104:107], a[60:63], a[28:31], v[104:107]
  v_mfma_f32_16x16x32_bf16 v[108:111], a[60:63], a[32:35], v[108:111]
  v_mfma_f32_16x16x32_bf16 v[112:115], a[60:63], a[36:39], v[112:115]
  v_mfma_f32_16x16x32_bf16 v[116:119], a[64:67], a[20:23], v[116:119]
  v_mfma_f32_16x16x32_bf16 v[120:123], a[64:67], a[24:27], v[120:123]
  v_mfma_f32_16x16x32_bf16 v[124:127], a[64:67], a[28:31], v[124:127]
  v_mfma_f32_16x16x32_bf16 v[128:131], a[64:67], a[32:35], v[128:131]
  v_mfma_f32_16x16x32_bf16 v[132:135], a[64:67], a[36:39], v[132:135]
  v_mfma_f32_16x16x32_bf16 v[136:139], a[68:71], a[20:23], v[136:139]
  v_mfma_f32_16x16x32_bf16 v[140:143], a[68:71], a[24:27], v[140:143]
  v_mfma_f32_16x16x32_bf16 v[144:147], a[68:71], a[28:31], v[144:147]
  v_mfma_f32_16x16x32_bf16 v[148:151], a[68:71], a[32:35], v[148:151]
  v_mfma_f32_16x16x32_bf16 v[152:155], a[68:71], a[36:39], v[152:155]
  v_mfma_f32_16x16x32_bf16 v[156:159], a[72:75], a[20:23], v[156:159]
  v_mfma_f32_16x16x32_bf16 v[160:163], a[72:75], a[24:27], v[160:163]
  v_mfma_f32_16x16x32_bf16 v[164:167], a[72:75], a[28:31], v[164:167]
  v_mfma_f32_16x16x32_bf16 v[168:171], a[72:75], a[32:35], v[168:171]
  v_mfma_f32_16x16x32_bf16 v[172:175], a[72:75], a[36:39], v[172:175]
  v_mfma_f32_16x16x32_bf16 v[176:179], a[76:79], a[20:23], v[176:179]
  v_mfma_f32_16x16x32_bf16 v[180:183], a[76:79], a[24:27], v[180:183]
  v_mfma_f32_16x16x32_bf16 v[184:187], a[76:79], a[28:31], v[184:187]
  s_mul_i32 s46, s55, 212992
  s_mul_i32 s47, s20, 13312
  s_add_u32 s46, s46, s47
  s_add_u32 s46, s46, 33554432
  s_add_u32 s16, s64, s46
  s_addc_u32 s17, s65, 0
  s_mov_b32 s18, 173056
  s_mov_b32 s19, 0x20000
  s_mov_b32 s52, s55
  s_mov_b32 s36, s52
  s_mul_i32 s29, s27, 53248
  s_nop 7
  v_cvt_pk_bf16_f32 v196, v96, v97
  v_cvt_pk_bf16_f32 v197, v98, v99
  v_cvt_pk_bf16_f32 v198, v100, v101
  v_cvt_pk_bf16_f32 v199, v102, v103
  s_add_u32 s45, s29, 0
  buffer_store_dwordx4 v[196:199], v16, s[16:19], s45 offen sc1
  v_cvt_pk_bf16_f32 v200, v104, v105
  v_cvt_pk_bf16_f32 v201, v106, v107
  v_cvt_pk_bf16_f32 v202, v108, v109
  v_cvt_pk_bf16_f32 v203, v110, v111
  s_add_u32 s45, s29, 1024
  buffer_store_dwordx4 v[200:203], v16, s[16:19], s45 offen sc1
  v_cvt_pk_bf16_f32 v204, v112, v113
  v_cvt_pk_bf16_f32 v205, v114, v115
  v_cvt_pk_bf16_f32 v206, v116, v117
  v_cvt_pk_bf16_f32 v207, v118, v119
  s_add_u32 s45, s29, 2048
  buffer_store_dwordx4 v[204:207], v16, s[16:19], s45 offen sc1
  v_cvt_pk_bf16_f32 v208, v120, v121
  v_cvt_pk_bf16_f32 v209, v122, v123
  v_cvt_pk_bf16_f32 v210, v124, v125
  v_cvt_pk_bf16_f32 v211, v126, v127
  s_add_u32 s45, s29, 3072
  buffer_store_dwordx4 v[208:211], v16, s[16:19], s45 offen sc1
  v_cvt_pk_bf16_f32 v196, v128, v129
  v_cvt_pk_bf16_f32 v197, v130, v131
  v_cvt_pk_bf16_f32 v198, v132, v133
  v_cvt_pk_bf16_f32 v199, v134, v135
  s_add_u32 s45, s29, 4096
  buffer_store_dwordx4 v[196:199], v16, s[16:19], s45 offen sc1
  v_cvt_pk_bf16_f32 v200, v136, v137
  v_cvt_pk_bf16_f32 v201, v138, v139
  v_cvt_pk_bf16_f32 v202, v140, v141
  v_cvt_pk_bf16_f32 v203, v142, v143
  s_add_u32 s45, s29, 5120
  buffer_store_dwordx4 v[200:203], v16, s[16:19], s45 offen sc1
  v_cvt_pk_bf16_f32 v204, v144, v145
  v_cvt_pk_bf16_f32 v205, v146, v147
  v_cvt_pk_bf16_f32 v206, v148, v149
  v_cvt_pk_bf16_f32 v207, v150, v151
  s_add_u32 s45, s29, 6144
  buffer_store_dwordx4 v[204:207], v16, s[16:19], s45 offen sc1
  v_cvt_pk_bf16_f32 v208, v152, v153
  v_cvt_pk_bf16_f32 v209, v154, v155
  v_cvt_pk_bf16_f32 v210, v156, v157
  v_cvt_pk_bf16_f32 v211, v158, v159
  s_add_u32 s45, s29, 7168
  buffer_store_dwordx4 v[208:211], v16, s[16:19], s45 offen sc1
  v_cvt_pk_bf16_f32 v196, v160, v161
  v_cvt_pk_bf16_f32 v197, v162, v163
  v_cvt_pk_bf16_f32 v198, v164, v165
  v_cvt_pk_bf16_f32 v199, v166, v167
  s_add_u32 s45, s29, 8192
  buffer_store_dwordx4 v[196:199], v16, s[16:19], s45 offen sc1
  v_cvt_pk_bf16_f32 v200, v168, v169
  v_cvt_pk_bf16_f32 v201, v170, v171
  v_cvt_pk_bf16_f32 v202, v172, v173
  v_cvt_pk_bf16_f32 v203, v174, v175
  s_add_u32 s45, s29, 9216
  buffer_store_dwordx4 v[200:203], v16, s[16:19], s45 offen sc1
  v_cvt_pk_bf16_f32 v204, v176, v177
  v_cvt_pk_bf16_f32 v205, v178, v179
  v_cvt_pk_bf16_f32 v206, v180, v181
  v_cvt_pk_bf16_f32 v207, v182, v183
  s_add_u32 s45, s29, 10240
  buffer_store_dwordx4 v[204:207], v16, s[16:19], s45 offen sc1
  v_cvt_pk_bf16_f32 v208, v184, v185
  v_cvt_pk_bf16_f32 v209, v186, v187
  v_cvt_pk_bf16_f32 v210, v188, v189
  v_cvt_pk_bf16_f32 v211, v190, v191
  s_add_u32 s45, s29, 11264
  buffer_store_dwordx4 v[208:211], v16, s[16:19], s45 offen sc1
  s_waitcnt vmcnt(0)
  s_barrier
  s_cmp_lg_u32 s20, 0
  s_cbranch_scc1 RS_wait
  s_add_u32 s45, s55, 64
  s_lshl_b32 s45, s45, 8
  v_mov_b32 v20, s45
  v_mov_b32 v21, 1
  v_cmp_eq_u32 vcc, 0, v1
  s_and_saveexec_b64 s[48:49], vcc
  buffer_atomic_add v21, v20, s[56:59], 0 offen sc1
  s_mov_b64 exec, s[48:49]
  s_mov_b32 s46, 0
RS_poll:
  buffer_load_dword v21, v20, s[56:59], 0 offen sc1
  s_waitcnt vmcnt(0)
  v_readfirstlane_b32 s47, v21
  s_add_u32 s46, s46, 1
  s_cmp_ge_u32 s47, 4
  s_cbranch_scc1 RS_wait
  s_cmp_ge_u32 s46, 200000
  s_cbranch_scc1 RS_wait
  s_sleep 1
  s_branch RS_poll
RS_wait:
  s_barrier
  s_add_u32 s45, s27, 0
  s_lshl_b32 s45, s45, 10
  s_add_u32 s46, s45, 0
  buffer_load_dwordx4 v[96:99], v16, s[16:19], s46 offen sc1
  s_add_u32 s46, s45, 53248
  buffer_load_dwordx4 v[100:103], v16, s[16:19], s46 offen sc1
  s_add_u32 s46, s45, 106496
  buffer_load_dwordx4 v[104:107], v16, s[16:19], s46 offen sc1
  s_add_u32 s46, s45, 159744
  buffer_load_dwordx4 v[108:111], v16, s[16:19], s46 offen sc1
  s_add_u32 s45, s27, 4
  s_lshl_b32 s45, s45, 10
  s_add_u32 s46, s45, 0
  buffer_load_dwordx4 v[112:115], v16, s[16:19], s46 offen sc1
  s_add_u32 s46, s45, 53248
  buffer_load_dwordx4 v[116:119], v16, s[16:19], s46 offen sc1
  s_add_u32 s46, s45, 106496
  buffer_load_dwordx4 v[120:123], v16, s[16:19], s46 offen sc1
  s_add_u32 s46, s45, 159744
  buffer_load_dwordx4 v[124:127], v16, s[16:19], s46 offen sc1
  s_add_u32 s45, s27, 8
  s_lshl_b32 s45, s45, 10
  s_add_u32 s46, s45, 0
  buffer_load_dwordx4 v[128:131], v16, s[16:19], s46 offen sc1
  s_add_u32 s46, s45, 53248
  buffer_load_dwordx4 v[132:135], v16, s[16:19], s46 offen sc1
  s_add_u32 s46, s45, 106496
  buffer_load_dwordx4 v[136:139], v16, s[16:19], s46 offen sc1
  s_add_u32 s46, s45, 159744
  buffer_load_dwordx4 v[140:143], v16, s[16:19], s46 offen sc1
  s_mul_i32 s45, s23, 160
  s_mul_i32 s46, s21, 80
  s_add_u32 s45, s45, s46
  s_mul_i32 s45, s45, 2304
  s_mul_i32 s46, s25, 1152
  s_add_u32 s45, s45, s46
  s_mul_i32 s46, s26, 288
  s_add_u32 s45, s45, s46
  s_mul_i32 s46, s22, 0
  s_add_u32 s45, s45, s46
  s_add_u32 s8, s72, s45
  s_addc_u32 s9, s73, 0
  s_lshl_b32 s46, s22, 5
  s_mov_b32 s10, 182304
  s_mov_b32 s11, 0x20000
  v_and_b32 v20, 15, v1
  v_mul_u32_u24 v20, 2304, v20
  v_lshrrev_b32 v21, 4, v1
  v_lshl_add_u32 v20, v21, 3, v20
  s_mov_b32 s50, 0xffff0000
  s_mov_b32 s52, 0x00003f80
  s_mov_b32 s53, 0x3f800000
  s_waitcnt vmcnt(8)
  v_lshlrev_b32 v160, 16, v96
  v_and_b32 v161, s50, v96
  v_lshlrev_b32 v168, 16, v100
  v_and_b32 v169, s50, v100
  v_add_f32 v160, v160, v168
  v_add_f32 v161, v161, v169
  v_lshlrev_b32 v168, 16, v104
  v_and_b32 v169, s50, v104
  v_add_f32 v160, v160, v168
  v_add_f32 v161, v161, v169
  v_lshlrev_b32 v168, 16, v108
  v_and_b32 v169, s50, v108
  v_add_f32 v160, v160, v168
  v_add_f32 v161, v161, v169
  v_lshlrev_b32 v162, 16, v97
  v_and_b32 v163, s50, v97
  v_lshlrev_b32 v168, 16, v101
  v_and_b32 v169, s50, v101
  v_add_f32 v162, v162, v168
  v_add_f32 v163, v163, v169
  v_lshlrev_b32 v168, 16, v105
  v_and_b32 v169, s50, v105
  v_add_f32 v162, v162, v168
  v_add_f32 v163, v163, v169
  v_lshlrev_b32 v168, 16, v109
  v_and_b32 v169, s50, v109
  v_add_f32 v162, v162, v168
  v_add_f32 v163, v163, v169
  v_lshlrev_b32 v164, 16, v98
  v_and_b32 v165, s50, v98
  v_lshlrev_b32 v168, 16, v102
  v_and_b32 v169, s50, v102
  v_add_f32 v164, v164, v168
  v_add_f32 v165, v165, v169
  v_lshlrev_b32 v168, 16, v106
  v_and_b32 v169, s50, v106
  v_add_f32 v164, v164, v168
  v_add_f32 v165, v165, v169
  v_lshlrev_b32 v168, 16, v110
  v_and_b32 v169, s50, v110
  v_add_f32 v164, v164, v168
  v_add_f32 v165, v165, v169
  v_lshlrev_b32 v166, 16, v99
  v_and_b32 v167, s50, v99
  v_lshlrev_b32 v168, 16, v103
  v_and_b32 v169, s50, v103
  v_add_f32 v166, v166, v168
  v_add_f32 v167, v167, v169
  v_lshlrev_b32 v168, 16, v107
  v_and_b32 v169, s50, v107
  v_add_f32 v166, v166, v168
  v_add_f32 v167, v167, v169
  v_lshlrev_b32 v168, 16, v111
  v_and_b32 v169, s50, v111
  v_add_f32 v166, v166, v168
  v_add_f32 v167, v167, v169
  v_cvt_pk_bf16_f32 v170, v160, v161
  v_cvt_pk_bf16_f32 v171, v162, v163
  s_lshl_b32 s45, s27, 1
  s_add_u32 s45, s45, 0
  s_mul_i32 s46, s45, 52429
  s_lshr_b32 s46, s46, 18
  s_mul_i32 s47, s46, 5
  s_sub_u32 s47, s45, s47
  s_mul_i32 s51, s22, 3
  s_add_u32 s47, s47, s51
  s_cmp_ge_u32 s47, 5
  s_cselect_b32 s51, 5, 0
  s_sub_u32 s47, s47, s51
  s_mul_i32 s47, s47, 36864
  s_lshl_b32 s51, s22, 2
  s_add_u32 s51, s51, s46
  s_cmp_ge_u32 s46, 4
  s_cselect_b32 s51, 8, s51
  s_lshl_b32 s51, s51, 5
  s_add_u32 s47, s47, s51
  s_add_u32 s51, s45, s22
  s_cmp_gt_u32 s51, 22
  s_cselect_b32 s51, 1, 0
  s_cmp_lt_u32 s45, 20
  s_cselect_b32 s51, 0, s51
  s_cmp_lg_u32 s51, 0
  s_cselect_b32 s47, 0x40000000, s47
  buffer_store_dwordx2 v[170:171], v20, s[8:11], s47 offen sc1
  v_cvt_pk_bf16_f32 v172, v164, v165
  v_cvt_pk_bf16_f32 v173, v166, v167
  s_lshl_b32 s45, s27, 1
  s_add_u32 s45, s45, 1
  s_mul_i32 s46, s45, 52429
  s_lshr_b32 s46, s46, 18
  s_mul_i32 s47, s46, 5
  s_sub_u32 s47, s45, s47
  s_mul_i32 s51, s22, 3
  s_add_u32 s47, s47, s51
  s_cmp_ge_u32 s47, 5
  s_cselect_b32 s51, 5, 0
  s_sub_u32 s47, s47, s51
  s_mul_i32 s47, s47, 36864
  s_lshl_b32 s51, s22, 2
  s_add_u32 s51, s51, s46
  s_cmp_ge_u32 s46, 4
  s_cselect_b32 s51, 8, s51
  s_lshl_b32 s51, s51, 5
  s_add_u32 s47, s47, s51
  s_add_u32 s51, s45, s22
  s_cmp_gt_u32 s51, 22
  s_cselect_b32 s51, 1, 0
  s_cmp_lt_u32 s45, 20
  s_cselect_b32 s51, 0, s51
  s_cmp_lg_u32 s51, 0
  s_cselect_b32 s47, 0x40000000, s47
  buffer_store_dwordx2 v[172:173], v20, s[8:11], s47 offen sc1
  s_waitcnt vmcnt(6)
  v_lshlrev_b32 v160, 16, v112
  v_and_b32 v161, s50, v112
  v_lshlrev_b32 v168, 16, v116
  v_and_b32 v169, s50, v116
  v_add_f32 v160, v160, v168
  v_add_f32 v161, v161, v169
  v_lshlrev_b32 v168, 16, v120
  v_and_b32 v169, s50, v120
  v_add_f32 v160, v160, v168
  v_add_f32 v161, v161, v169
  v_lshlrev_b32 v168, 16, v124
  v_and_b32 v169, s50, v124
  v_add_f32 v160, v160, v168
  v_add_f32 v161, v161, v169
  v_lshlrev_b32 v162, 16, v113
  v_and_b32 v163, s50, v113
  v_lshlrev_b32 v168, 16, v117
  v_and_b32 v169, s50, v117
  v_add_f32 v162, v162, v168
  v_add_f32 v163, v163, v169
  v_lshlrev_b32 v168, 16, v121
  v_and_b32 v169, s50, v121
  v_add_f32 v162, v162, v168
  v_add_f32 v163, v163, v169
  v_lshlrev_b32 v168, 16, v125
  v_and_b32 v169, s50, v125
  v_add_f32 v162, v162, v168
  v_add_f32 v163, v163, v169
  v_lshlrev_b32 v164, 16, v114
  v_and_b32 v165, s50, v114
  v_lshlrev_b32 v168, 16, v118
  v_and_b32 v169, s50, v118
  v_add_f32 v164, v164, v168
  v_add_f32 v165, v165, v169
  v_lshlrev_b32 v168, 16, v122
  v_and_b32 v169, s50, v122
  v_add_f32 v164, v164, v168
  v_add_f32 v165, v165, v169
  v_lshlrev_b32 v168, 16, v126
  v_and_b32 v169, s50, v126
  v_add_f32 v164, v164, v168
  v_add_f32 v165, v165, v169
  v_lshlrev_b32 v166, 16, v115
  v_and_b32 v167, s50, v115
  v_lshlrev_b32 v168, 16, v119
  v_and_b32 v169, s50, v119
  v_add_f32 v166, v166, v168
  v_add_f32 v167, v167, v169
  v_lshlrev_b32 v168, 16, v123
  v_and_b32 v169, s50, v123
  v_add_f32 v166, v166, v168
  v_add_f32 v167, v167, v169
  v_lshlrev_b32 v168, 16, v127
  v_and_b32 v169, s50, v127
  v_add_f32 v166, v166, v168
  v_add_f32 v167, v167, v169
  v_cvt_pk_bf16_f32 v174, v160, v161
  v_cvt_pk_bf16_f32 v175, v162, v163
  s_lshl_b32 s45, s27, 1
  s_add_u32 s45, s45, 8
  s_mul_i32 s46, s45, 52429
  s_lshr_b32 s46, s46, 18
  s_mul_i32 s47, s46, 5
  s_sub_u32 s47, s45, s47
  s_mul_i32 s51, s22, 3
  s_add_u32 s47, s47, s51
  s_cmp_ge_u32 s47, 5
  s_cselect_b32 s51, 5, 0
  s_sub_u32 s47, s47, s51
  s_mul_i32 s47, s47, 36864
  s_lshl_b32 s51, s22, 2
  s_add_u32 s51, s51, s46
  s_cmp_ge_u32 s46, 4
  s_cselect_b32 s51, 8, s51
  s_lshl_b32 s51, s51, 5
  s_add_u32 s47, s47, s51
  s_add_u32 s51, s45, s22
  s_cmp_gt_u32 s51, 22
  s_cselect_b32 s51, 1, 0
  s_cmp_lt_u32 s45, 20
  s_cselect_b32 s51, 0, s51
  s_cmp_lg_u32 s51, 0
  s_cselect_b32 s47, 0x40000000, s47
  buffer_store_dwordx2 v[174:175], v20, s[8:11], s47 offen sc1
  v_cvt_pk_bf16_f32 v176, v164, v165
  v_cvt_pk_bf16_f32 v177, v166, v167
  s_lshl_b32 s45, s27, 1
  s_add_u32 s45, s45, 9
  s_mul_i32 s46, s45, 52429
  s_lshr_b32 s46, s46, 18
  s_mul_i32 s47, s46, 5
  s_sub_u32 s47, s45, s47
  s_mul_i32 s51, s22, 3
  s_add_u32 s47, s47, s51
  s_cmp_ge_u32 s47, 5
  s_cselect_b32 s51, 5, 0
  s_sub_u32 s47, s47, s51
  s_mul_i32 s47, s47, 36864
  s_lshl_b32 s51, s22, 2
  s_add_u32 s51, s51, s46
  s_cmp_ge_u32 s46, 4
  s_cselect_b32 s51, 8, s51
  s_lshl_b32 s51, s51, 5
  s_add_u32 s47, s47, s51
  s_add_u32 s51, s45, s22
  s_cmp_gt_u32 s51, 22
  s_cselect_b32 s51, 1, 0
  s_cmp_lt_u32 s45, 20
  s_cselect_b32 s51, 0, s51
  s_cmp_lg_u32 s51, 0
  s_cselect_b32 s47, 0x40000000, s47
  buffer_store_dwordx2 v[176:177], v20, s[8:11], s47 offen sc1
  s_waitcnt vmcnt(4)
  v_lshlrev_b32 v160, 16, v128
  v_and_b32 v161, s50, v128
  v_lshlrev_b32 v168, 16, v132
  v_and_b32 v169, s50, v132
  v_add_f32 v160, v160, v168
  v_add_f32 v161, v161, v169
  v_lshlrev_b32 v168, 16, v136
  v_and_b32 v169, s50, v136
  v_add_f32 v160, v160, v168
  v_add_f32 v161, v161, v169
  v_lshlrev_b32 v168, 16, v140
  v_and_b32 v169, s50, v140
  v_add_f32 v160, v160, v168
  v_add_f32 v161, v161, v169
  v_lshlrev_b32 v162, 16, v129
  v_and_b32 v163, s50, v129
  v_lshlrev_b32 v168, 16, v133
  v_and_b32 v169, s50, v133
  v_add_f32 v162, v162, v168
  v_add_f32 v163, v163, v169
  v_lshlrev_b32 v168, 16, v137
  v_and_b32 v169, s50, v137
  v_add_f32 v162, v162, v168
  v_add_f32 v163, v163, v169
  v_lshlrev_b32 v168, 16, v141
  v_and_b32 v169, s50, v141
  v_add_f32 v162, v162, v168
  v_add_f32 v163, v163, v169
  v_lshlrev_b32 v164, 16, v130
  v_and_b32 v165, s50, v130
  v_lshlrev_b32 v168, 16, v134
  v_and_b32 v169, s50, v134
  v_add_f32 v164, v164, v168
  v_add_f32 v165, v165, v169
  v_lshlrev_b32 v168, 16, v138
  v_and_b32 v169, s50, v138
  v_add_f32 v164, v164, v168
  v_add_f32 v165, v165, v169
  v_lshlrev_b32 v168, 16, v142
  v_and_b32 v169, s50, v142
  v_add_f32 v164, v164, v168
  v_add_f32 v165, v165, v169
  v_lshlrev_b32 v166, 16, v131
  v_and_b32 v167, s50, v131
  v_lshlrev_b32 v168, 16, v135
  v_and_b32 v169, s50, v135
  v_add_f32 v166, v166, v168
  v_add_f32 v167, v167, v169
  v_lshlrev_b32 v168, 16, v139
  v_and_b32 v169, s50, v139
  v_add_f32 v166, v166, v168
  v_add_f32 v167, v167, v169
  v_lshlrev_b32 v168, 16, v143
  v_and_b32 v169, s50, v143
  v_add_f32 v166, v166, v168
  v_add_f32 v167, v167, v169
  v_cvt_pk_bf16_f32 v170, v160, v161
  v_cvt_pk_bf16_f32 v171, v162, v163
  s_lshl_b32 s45, s27, 1
  s_add_u32 s45, s45, 16
  s_mul_i32 s46, s45, 52429
  s_lshr_b32 s46, s46, 18
  s_mul_i32 s47, s46, 5
  s_sub_u32 s47, s45, s47
  s_mul_i32 s51, s22, 3
  s_add_u32 s47, s47, s51
  s_cmp_ge_u32 s47, 5
  s_cselect_b32 s51, 5, 0
  s_sub_u32 s47, s47, s51
  s_mul_i32 s47, s47, 36864
  s_lshl_b32 s51, s22, 2
  s_add_u32 s51, s51, s46
  s_cmp_ge_u32 s46, 4
  s_cselect_b32 s51, 8, s51
  s_lshl_b32 s51, s51, 5
  s_add_u32 s47, s47, s51
  s_add_u32 s51, s45, s22
  s_cmp_gt_u32 s51, 22
  s_cselect_b32 s51, 1, 0
  s_cmp_lt_u32 s45, 20
  s_cselect_b32 s51, 0, s51
  s_cmp_lg_u32 s51, 0
  s_cselect_b32 s47, 0x40000000, s47
  buffer_store_dwordx2 v[170:171], v20, s[8:11], s47 offen sc1
  v_cvt_pk_bf16_f32 v172, v164, v165
  v_cvt_pk_bf16_f32 v173, v166, v167
  s_lshl_b32 s45, s27, 1
  s_add_u32 s45, s45, 17
  s_mul_i32 s46, s45, 52429
  s_lshr_b32 s46, s46, 18
  s_mul_i32 s47, s46, 5
  s_sub_u32 s47, s45, s47
  s_mul_i32 s51, s22, 3
  s_add_u32 s47, s47, s51
  s_cmp_ge_u32 s47, 5
  s_cselect_b32 s51, 5, 0
  s_sub_u32 s47, s47, s51
  s_mul_i32 s47, s47, 36864
  s_lshl_b32 s51, s22, 2
  s_add_u32 s51, s51, s46
  s_cmp_ge_u32 s46, 4
  s_cselect_b32 s51, 8, s51
  s_lshl_b32 s51, s51, 5
  s_add_u32 s47, s47, s51
  s_add_u32 s51, s45, s22
  s_cmp_gt_u32 s51, 22
  s_cselect_b32 s51, 1, 0
  s_cmp_lt_u32 s45, 20
  s_cselect_b32 s51, 0, s51
  s_cmp_lg_u32 s51, 0
  s_cselect_b32 s47, 0x40000000, s47
  buffer_store_dwordx2 v[172:173], v20, s[8:11], s47 offen sc1
K1_END:
  s_endpgm
KERNEL_COLD_END:
K1_FALLBACK:
  s_waitcnt vmcnt(0) lgkmcnt(0)
  s_barrier
  s_mov_b32 s37, 1
  v_mov_b32 v20, 0xff800000
  v_mov_b32 v21, 0xff800000
  v_mov_b32 v22, 0xff800000
  v_mov_b32 v23, 0xff800000
  v_mov_b32 v24, 0xff800000
  s_mov_b32 s36, 0
  s_mov_b32 s40, 0
FB_loop:
  s_cmp_lg_u32 s21, 0
  s_cbranch_scc1 FB_nok
  s_add_u32 m0, s39, 0
  s_nop 0
  buffer_load_dwordx4 v48, s[12:15], s36 offen offset:0 nt lds
  buffer_load_dwordx4 v49, s[12:15], s36 offen offset:1024 nt lds
  buffer_load_dwordx4 v50, s[12:15], s36 offen offset:2048 nt lds
  buffer_load_dwordx4 v51, s[12:15], s36 offen offset:3072 nt lds
  s_add_u32 s36, s36, 4096
  s_add_u32 m0, s39, 4096
  s_nop 0
  buffer_load_dwordx4 v48, s[12:15], s36 offen offset:0 nt lds
  buffer_load_dwordx4 v49, s[12:15], s36 offen offset:1024 nt lds
  buffer_load_dwordx4 v50, s[12:15], s36 offen offset:2048 nt lds
  buffer_load_dwordx4 v51, s[12:15], s36 offen offset:3072 nt lds
  s_add_u32 s36, s36, 4096
FB_nok:
  s_waitcnt vmcnt(0)
  s_barrier
  ds_read_b128 a[80:83], v36 offset:0
  ds_read_b128 a[96:99], v36 offset:4096
  ds_read_b128 a[84:87], v37 offset:0
  ds_read_b128 a[100:103], v37 offset:4096
  ds_read_b128 a[88:91], v38 offset:0
  ds_read_b128 a[104:107], v38 offset:4096
  ds_read_b128 a[92:95], v39 offset:0
  ds_read_b128 a[108:111], v39 offset:4096
  s_waitcnt lgkmcnt(0)
  v_mfma_f32_16x16x32_bf16 v[80:83], a[80:83], a[0:3], v[52:55]
  v_mfma_f32_16x16x32_bf16 v[84:87], a[96:99], a[0:3], v[52:55]
  v_mfma_f32_16x16x32_bf16 v[80:83], a[84:87], a[4:7], v[80:83]
  v_mfma_f32_16x16x32_bf16 v[84:87], a[100:103], a[4:7], v[84:87]
  v_mfma_f32_16x16x32_bf16 v[80:83], a[88:91], a[8:11], v[80:83]
  v_mfma_f32_16x16x32_bf16 v[84:87], a[104:107], a[8:11], v[84:87]
  v_mfma_f32_16x16x32_bf16 v[80:83], a[92:95], a[12:15], v[80:83]
  v_mfma_f32_16x16x32_bf16 v[84:87], a[108:111], a[12:15], v[84:87]
  s_nop 7
  s_nop 1
  v_max3_f32 v20, v20, v80, v81
  v_max3_f32 v20, v20, v82, v83
  v_max3_f32 v20, v20, v84, v85
  v_max3_f32 v20, v20, v86, v87
  s_nop 1
  v_mfma_f32_16x16x32_bf16 v[80:83], a[80:83], a[16:19], v[56:59]
  v_mfma_f32_16x16x32_bf16 v[84:87], a[96:99], a[16:19], v[56:59]
  v_mfma_f32_16x16x32_bf16 v[80:83], a[84:87], a[20:23], v[80:83]
  v_mfma_f32_16x16x32_bf16 v[84:87], a[100:103], a[20:23], v[84:87]
  v_mfma_f32_16x16x32_bf16 v[80:83], a[88:91], a[24:27], v[80:83]
  v_mfma_f32_16x16x32_bf16 v[84:87], a[104:107], a[24:27], v[84:87]
  v_mfma_f32_16x16x32_bf16 v[80:83], a[92:95], a[28:31], v[80:83]
  v_mfma_f32_16x16x32_bf16 v[84:87], a[108:111], a[28:31], v[84:87]
  s_nop 7
  s_nop 1
  v_max3_f32 v21, v21, v80, v81
  v_max3_f32 v21, v21, v82, v83
  v_max3_f32 v21, v21, v84, v85
  v_max3_f32 v21, v21, v86, v87
  s_nop 1
  v_mfma_f32_16x16x32_bf16 v[80:83], a[80:83], a[32:35], v[60:63]
  v_mfma_f32_16x16x32_bf16 v[84:87], a[96:99], a[32:35], v[60:63]
  v_mfma_f32_16x16x32_bf16 v[80:83], a[84:87], a[36:39], v[80:83]
  v_mfma_f32_16x16x32_bf16 v[84:87], a[100:103], a[36:39], v[84:87]
  v_mfma_f32_16x16x32_bf16 v[80:83], a[88:91], a[40:43], v[80:83]
  v_mfma_f32_16x16x32_bf16 v[84:87], a[104:107], a[40:43], v[84:87]
  v_mfma_f32_16x16x32_bf16 v[80:83], a[92:95], a[44:47], v[80:83]
  v_mfma_f32_16x16x32_bf16 v[84:87], a[108:111], a[44:47], v[84:87]
  s_nop 7
  s_nop 1
  v_max3_f32 v22, v22, v80, v81
  v_max3_f32 v22, v22, v82, v83
  v_max3_f32 v22, v22, v84, v85
  v_max3_f32 v22, v22, v86, v87
  s_nop 1
  v_mfma_f32_16x16x32_bf16 v[80:83], a[80:83], a[48:51], v[64:67]
  v_mfma_f32_16x16x32_bf16 v[84:87], a[96:99], a[48:51], v[64:67]
  v_mfma_f32_16x16x32_bf16 v[80:83], a[84:87], a[52:55], v[80:83]
  v_mfma_f32_16x16x32_bf16 v[84:87], a[100:103], a[52:55], v[84:87]
  v_mfma_f32_16x16x32_bf16 v[80:83], a[88:91], a[56:59], v[80:83]
  v_mfma_f32_16x16x32_bf16 v[84:87], a[104:107], a[56:59], v[84:87]
  v_mfma_f32_16x16x32_bf16 v[80:83], a[92:95], a[60:63], v[80:83]
  v_mfma_f32_16x16x32_bf16 v[84:87], a[108:111], a[60:63], v[84:87]
  s_nop 7
  s_nop 1
  v_max3_f32 v23, v23, v80, v81
  v_max3_f32 v23, v23, v82, v83
  v_max3_f32 v23, v23, v84, v85
  v_max3_f32 v23, v23, v86, v87
  s_nop 1
  v_mfma_f32_16x16x32_bf16 v[80:83], a[80:83], a[64:67], v[68:71]
  v_mfma_f32_16x16x32_bf16 v[84:87], a[96:99], a[64:67], v[68:71]
  v_mfma_f32_16x16x32_bf16 v[80:83], a[84:87], a[68:71], v[80:83]
  v_mfma_f32_16x16x32_bf16 v[84:87], a[100:103], a[68:71], v[84:87]
  v_mfma_f32_16x16x32_bf16 v[80:83], a[88:91], a[72:75], v[80:83]
  v_mfma_f32_16x16x32_bf16 v[84:87], a[104:107], a[72:75], v[84:87]
  v_mfma_f32_16x16x32_bf16 v[80:83], a[92:95], a[76:79], v[80:83]
  v_mfma_f32_16x16x32_bf16 v[84:87], a[108:111], a[76:79], v[84:87]
  s_nop 7
  s_nop 1
  v_max3_f32 v24, v24, v80, v81
  v_max3_f32 v24, v24, v82, v83
  v_max3_f32 v24, v24, v84, v85
  v_max3_f32 v24, v24, v86, v87
  s_nop 1
  s_barrier
  s_add_u32 s40, s40, 1
  s_cmp_lt_u32 s40, 32
  s_cbranch_scc1 FB_loop
  v_xor_b32 v26, 16, v1
  v_lshlrev_b32 v26, 2, v26
  ds_bpermute_b32 v28, v26, v20
  ds_bpermute_b32 v29, v26, v21
  ds_bpermute_b32 v30, v26, v22
  ds_bpermute_b32 v31, v26, v23
  ds_bpermute_b32 v32, v26, v24
  s_waitcnt lgkmcnt(0)
  v_max_f32 v20, v20, v28
  v_max_f32 v21, v21, v29
  v_max_f32 v22, v22, v30
  v_max_f32 v23, v23, v31
  v_max_f32 v24, v24, v32
  v_xor_b32 v26, 32, v1
  v_lshlrev_b32 v26, 2, v26
  ds_bpermute_b32 v28, v26, v20
  ds_bpermute_b32 v29, v26, v21
  ds_bpermute_b32 v30, v26, v22
  ds_bpermute_b32 v31, v26, v23
  ds_bpermute_b32 v32, v26, v24
  s_waitcnt lgkmcnt(0)
  v_max_f32 v20, v20, v28
  v_max_f32 v21, v21, v29
  v_max_f32 v22, v22, v30
  v_max_f32 v23, v23, v31
  v_max_f32 v24, v24, v32
  v_sub_f32 v52, 0, v20
  v_sub_f32 v53, 0, v20
  v_sub_f32 v54, 0, v20
  v_sub_f32 v55, 0, v20
  v_sub_f32 v56, 0, v21
  v_sub_f32 v57, 0, v21
  v_sub_f32 v58, 0, v21
  v_sub_f32 v59, 0, v21
  v_sub_f32 v60, 0, v22
  v_sub_f32 v61, 0, v22
  v_sub_f32 v62, 0, v22
  v_sub_f32 v63, 0, v22
  v_sub_f32 v64, 0, v23
  v_sub_f32 v65, 0, v23
  v_sub_f32 v66, 0, v23
  v_sub_f32 v67, 0, v23
  v_sub_f32 v68, 0, v24
  v_sub_f32 v69, 0, v24
  v_sub_f32 v70, 0, v24
  v_sub_f32 v71, 0, v24
  s_mov_b32 s36, 0
  s_add_u32 m0, s39, 0
  s_nop 0
  buffer_load_dwordx4 v48, s[12:15], s36 offen offset:0 nt lds
  buffer_load_dwordx4 v49, s[12:15], s36 offen offset:1024 nt lds
  buffer_load_dwordx4 v50, s[12:15], s36 offen offset:2048 nt lds
  buffer_load_dwordx4 v51, s[12:15], s36 offen offset:3072 nt lds
  s_add_u32 s36, s36, 4096
  s_add_u32 m0, s39, 4096
  s_nop 0
  buffer_load_dwordx4 v48, s[12:15], s36 offen offset:0 nt lds
  buffer_load_dwordx4 v49, s[12:15], s36 offen offset:1024 nt lds
  buffer_load_dwordx4 v50, s[12:15], s36 offen offset:2048 nt lds
  buffer_load_dwordx4 v51, s[12:15], s36 offen offset:3072 nt lds
  s_add_u32 s36, s36, 4096
  s_add_u32 m0, s39, 16384
  s_nop 0
  buffer_load_dwordx4 v48, s[12:15], s36 offen offset:0 nt lds
  buffer_load_dwordx4 v49, s[12:15], s36 offen offset:1024 nt lds
  buffer_load_dwordx4 v50, s[12:15], s36 offen offset:2048 nt lds
  buffer_load_dwordx4 v51, s[12:15], s36 offen offset:3072 nt lds
  s_add_u32 s36, s36, 4096
  s_add_u32 m0, s39, 20480
  s_nop 0
  buffer_load_dwordx4 v48, s[12:15], s36 offen offset:0 nt lds
  buffer_load_dwordx4 v49, s[12:15], s36 offen offset:1024 nt lds
  buffer_load_dwordx4 v50, s[12:15], s36 offen offset:2048 nt lds
  buffer_load_dwordx4 v51, s[12:15], s36 offen offset:3072 nt lds
  s_add_u32 s36, s36, 4096
  s_add_u32 m0, s39, 32768
  s_nop 0
  buffer_load_dwordx4 v48, s[12:15], s36 offen offset:0 nt lds
  buffer_load_dwordx4 v49, s[12:15], s36 offen offset:1024 nt lds
  buffer_load_dwordx4 v50, s[12:15], s36 offen offset:2048 nt lds
  buffer_load_dwordx4 v51, s[12:15], s36 offen offset:3072 nt lds
  s_add_u32 s36, s36, 4096
  s_add_u32 m0, s39, 36864
  s_nop 0
  buffer_load_dwordx4 v48, s[12:15], s36 offen offset:0 nt lds
  buffer_load_dwordx4 v49, s[12:15], s36 offen offset:1024 nt lds
  buffer_load_dwordx4 v50, s[12:15], s36 offen offset:2048 nt lds
  buffer_load_dwordx4 v51, s[12:15], s36 offen offset:3072 nt lds
  s_add_u32 s36, s36, 4096
  s_add_u32 m0, s39, 49152
  s_nop 0
  buffer_load_dwordx4 v48, s[12:15], s36 offen offset:0 nt lds
  buffer_load_dwordx4 v49, s[12:15], s36 offen offset:1024 nt lds
  buffer_load_dwordx4 v50, s[12:15], s36 offen offset:2048 nt lds
  buffer_load_dwordx4 v51, s[12:15], s36 offen offset:3072 nt lds
  s_add_u32 s36, s36, 4096
  s_add_u32 m0, s39, 53248
  s_nop 0
  buffer_load_dwordx4 v48, s[12:15], s36 offen offset:0 nt lds
  buffer_load_dwordx4 v49, s[12:15], s36 offen offset:1024 nt lds
  buffer_load_dwordx4 v50, s[12:15], s36 offen offset:2048 nt lds
  buffer_load_dwordx4 v51, s[12:15], s36 offen offset:3072 nt lds
  s_add_u32 s36, s36, 4096
  s_lshl_b32 s32, s26, 3
  s_branch K1_ATTPRO
.section .rodata,"a"
.p2align 6
.amdhsa_kernel concat_heads__mha_block_cached__gqa_block_cached__near_ridge_kernel
  .amdhsa_next_free_vgpr 512
  .amdhsa_next_free_sgpr 96
  .amdhsa_accum_offset 256
  .amdhsa_group_segment_fixed_size 0
  .amdhsa_kernarg_size 104
  .amdhsa_user_sgpr_count 2
  .amdhsa_user_sgpr_kernarg_segment_ptr 1
  .amdhsa_system_sgpr_workgroup_id_x 1
.end_amdhsa_kernel
.text
```
